```python
import torch

def _softmax(x, axis=-1):
    return torch.softmax(x, dim=axis)

def _gelu(x):
    return torch.nn.functional.gelu(x, approximate='tanh')

def _silu(x):
    return torch.nn.functional.silu(x)

def _sigmoid(x):
    return torch.sigmoid(x)

def _layernorm(x, axis=-1, eps=1e-05):
    m = x.mean(dim=axis, keepdim=True)
    v = x.var(dim=axis, keepdim=True, unbiased=False)
    return (x - m) / torch.sqrt(v + eps)

def _scatter_add(tgt, idx, src, axis=0):
    return tgt.clone().index_add_(axis, idx, src)

def _segment_sum(src, seg, n):
    out = torch.zeros((n,) + src.shape[1:], dtype=src.dtype)
    return out.index_add_(0, seg, src)

def _pad(x, pw):
    flat = tuple((v for pair in reversed(pw) for v in pair))
    return torch.nn.functional.pad(x, flat)
kernel_name = 'standalone__autoregressive_conv_wavernn__speech'

def setup_inputs():

    _w = lambda a: (lambda t: t.to(torch.bfloat16) if t.is_floating_point() else t)(torch.as_tensor(a))
    B, T, D, K = (2, 16000, 256, 3)
    return {'x': _w((lambda *s: torch.randn(*s, dtype=torch.bfloat16) * 0.1)(B, T, D)), 'w': _w((lambda *s: torch.randn(*s, dtype=torch.bfloat16) * 0.1)(K, D, 2 * D))}

def reference(x, w):
    B, T, D = x.shape
    K = w.shape[0]
    dil = 2
    pad = (K - 1) * dil
    xp = _pad(x, ((0, 0), (pad, 0), (0, 0)))
    h = torch.einsum('btd,de->bte', xp[:, 0:T, :], w[0])
    for i in range(1, K):
        h = h + torch.einsum('btd,de->bte', xp[:, i * dil:i * dil + T, :], w[i])
    f, g = (h[..., :D].clone(), h[..., D:].clone())
    return torch.tanh(f) * _sigmoid(g)
```

```asm
; @launch grid=(256,1,1) block=(256,1,1) lds=163840
.amdgcn_target "amdgcn-amd-amdhsa--gfx950"
.text
.globl standalone__autoregressive_conv_wavernn__speech_kernel
.p2align 12
.p2align 8
.type standalone__autoregressive_conv_wavernn__speech_kernel,@function
standalone__autoregressive_conv_wavernn__speech_kernel:
    s_cmp_ge_u32 s2, 256
    s_cbranch_scc1 L_end
    s_load_dwordx2 s[12:13], s[0:1], 0
    s_load_dwordx2 s[16:17], s[0:1], 8
    s_load_dwordx2 s[20:21], s[0:1], 16
    v_lshrrev_b32 v25, 6, v0
    s_and_b32 s29, s2, 7
    s_lshr_b32 s30, s2, 5
    v_readfirstlane_b32 s24, v25
    s_bfe_u32 s25, s2, 0x20003
    s_xor_b32 s8, s30, s25
    s_and_b32 s8, s8, 3
    s_lshl_b32 s9, s8, 7
    s_lshl_b32 s8, s8, 16
    s_lshl_b32 s38, s24, 12
    s_lshl_b32 s39, s24, 14
    v_lshrrev_b32 v25, 4, v0
    v_and_b32 v26, 1, v0
    v_lshlrev_b32 v25, 12, v25
    v_lshl_or_b32 v25, v26, 4, v25
    v_bfe_u32 v26, v0, 1, 2
    v_lshrrev_b32 v27, 2, v0
    v_lshl_or_b32 v25, v26, 5, v25
    v_xor_b32 v27, v27, v0
    s_lshl_b32 s3, s25, 7
    v_and_b32 v27, 8, v27
    s_mov_b32 s18, 786432
    v_lshl_or_b32 v25, v27, 6, v25
    s_mov_b32 s19, 0x20000
    v_or_b32 v5, s3, v25
    v_xor_b32 v6, 32, v5
    v_xor_b32 v7, 64, v5
    v_xor_b32 v8, 0x60, v5
    s_add_u32 m0, s38, 65536
    s_xor_b32 s37, s8, 0
    s_waitcnt lgkmcnt(0)
    buffer_load_dwordx4 v5, s[16:19], s37 offen offset:0  lds
    s_lshl3_add_u32 s29, s29, s30
    s_and_b32 s26, s29, 15
    s_lshr_b32 s27, s29, 5
    s_bfe_u32 s28, s29, 0x10004
    s_mul_i32 s29, s27, 8192000
    buffer_load_dwordx4 v6, s[16:19], s37 offen offset:1024  lds
    s_lshl_b32 s30, s26, 19
    s_add_u32 s29, s29, s30
    s_lshl_b32 s30, s28, 9
    s_add_u32 s29, s29, s30
    v_bfe_u32 v29, v0, 4, 2
    buffer_load_dwordx4 v7, s[16:19], s37 offen offset:2048  lds
    v_bfe_u32 v30, v0, 5, 1
    s_lshl_b32 s4, s24, 10
    v_xor_b32 v29, v29, v30
    v_and_b32 v30, 7, v0
    s_add_u32 s4, s4, s29
    buffer_load_dwordx4 v8, s[16:19], s37 offen offset:3072  lds
    v_xor_b32 v29, v29, v30
    v_bfe_u32 v28, v0, 3, 3
    s_add_u32 s4, s4, 0xfffff800
    v_lshlrev_b32 v29, 4, v29
    s_add_u32 s5, s4, 130048
    v_lshl_or_b32 v29, v28, 14, v29
    s_add_u32 s6, s4, 260096
    v_xor_b32 v30, 0x50, v29
    s_add_u32 s7, s4, 390144
    v_add_u32 v9, s4, v29
    s_lshr_b32 s4, s24, 1
    v_add_u32 v10, s5, v30
    s_or_b32 s4, s4, s26
    v_add_u32 v11, s6, v29
    s_cmp_eq_u32 s4, 0
    v_add_u32 v12, s7, v30
    s_cselect_b32 s4, 0x80000000, 0
    v_add_u32 v28, -1, v28
    s_mov_b32 s14, 16384000
    s_mov_b32 s15, 0x20000
    v_and_or_b32 v9, v28, s4, v9
    s_add_u32 m0, s39, 0
    s_xor_b32 s35, s9, 0
    buffer_load_dwordx4 v9, s[12:15], s35 offen offset:0  lds
    buffer_load_dwordx4 v10, s[12:15], s35 offen offset:1024  lds
    buffer_load_dwordx4 v11, s[12:15], s35 offen offset:2048  lds
    buffer_load_dwordx4 v12, s[12:15], s35 offen offset:3072  lds
    s_add_u32 m0, s38, 81920
    s_xor_b32 s37, s8, 65536
    buffer_load_dwordx4 v5, s[16:19], s37 offen offset:0  lds
    buffer_load_dwordx4 v6, s[16:19], s37 offen offset:1024  lds
    buffer_load_dwordx4 v7, s[16:19], s37 offen offset:2048  lds
    buffer_load_dwordx4 v8, s[16:19], s37 offen offset:3072  lds
    v_bfe_u32 v25, v0, 5, 1
    v_and_b32 v26, 31, v0
    s_lshl_b32 s30, s24, 17
    v_xor_b32 v26, v26, v25
    s_add_u32 s30, s30, s29
    v_lshlrev_b32 v26, 4, v26
    s_lshl_b32 s3, s24, 7
    v_lshl_or_b32 v26, v25, 14, v26
    s_and_b32 s3, s3, 128
    s_xor_b32 s3, s3, s9
    s_cmp_eq_u32 s26, 15
    s_cselect_b32 s31, s24, 0
    v_xor_b32 v26, s3, v26
    s_cmp_eq_u32 s31, 3
    s_cselect_b32 s4, 0x80000000, s30
    s_cmp_ge_u32 s31, 2
    s_cselect_b32 s6, 0x80000000, s30
    v_add_u32 v1, s4, v26
    s_add_u32 s5, s4, 31744
    s_add_u32 s7, s6, 95232
    s_add_u32 s6, s6, 63488
    v_xad_u32 v2, v26, 32, s5
    v_xad_u32 v3, v26, 64, s6
    v_xor_b32 v26, 64, v26
    v_xad_u32 v4, v26, 32, s7
    v_and_b32 v0, 63, v0
    s_mov_b32 s22, 16384000
    s_mov_b32 s23, 0x20000
    v_and_b32 v25, 15, v0
    v_lshrrev_b32 v26, 4, v0
    v_xor_b32 v27, v25, v26
    v_lshlrev_b32 v27, 4, v27
    v_lshl_add_u32 v13, v25, 9, v27
    v_xor_b32 v14, 64, v13
    v_xor_b32 v15, 128, v13
    v_xor_b32 v16, 192, v13
    v_bfe_u32 v25, v0, 1, 3
    v_bfe_u32 v26, v0, 2, 1
    v_bfe_u32 v27, v0, 3, 1
    v_xor_b32 v26, v26, v27
    v_xor_b32 v25, v25, v26
    v_lshrrev_b32 v26, 4, v0
    v_xor_b32 v25, v25, v26
    v_lshlrev_b32 v25, 4, v25
    v_and_b32 v26, 15, v0
    v_lshl_or_b32 v40, v26, 7, v25
    v_xor_b32 v41, 64, v40
    v_bfe_u32 v25, v0, 2, 2
    v_bfe_u32 v26, v0, 4, 1
    v_lshlrev_b32 v27, 2, v26
    v_xor_b32 v27, s24, v27
    v_xor_b32 v27, v27, v25
    v_lshlrev_b32 v27, 5, v27
    v_lshl_add_u32 v27, v25, 10, v27
    v_lshl_add_u32 v27, v26, 9, v27
    v_lshrrev_b32 v25, 5, v0
    v_lshl_add_u32 v27, v25, 12, v27
    v_and_b32 v25, 1, v0
    v_lshl_add_u32 v27, v25, 4, v27
    v_and_b32 v25, 2, v0
    v_lshl_add_u32 v27, v25, 2, v27
    v_add_u32 v17, 0x10000, v27
    v_xor_b32 v18, 128, v17
    v_add_u32 v19, 0x10000, v17
    v_add_u32 v20, 0x10000, v18
    v_lshrrev_b32 v25, 5, v0
    v_and_b32 v26, 15, v0
    v_lshl_add_u32 v25, v25, 4, v26
    v_bfe_u32 v26, v0, 4, 1
    s_lshl_b32 s30, s25, 7
    s_add_u32 s30, s30, s29
    s_lshl_b32 s3, s24, 5
    s_add_u32 s40, s3, s30
    v_lshlrev_b32 v27, 14, v25
    v_lshl_add_u32 v27, v26, 4, v27
    v_add_u32 v27, s40, v27
    s_cmp_eq_u32 s26, 15
    s_cselect_b32 s31, 20, 32
    v_cmp_gt_u32 vcc, s31, v25
    v_mov_b32 v21, 0x80000000
    s_nop 0
    v_cndmask_b32 v21, v21, v27, vcc
    s_lshl_b32 s3, s24, 1
    v_add_u32 v26, s3, v26
    v_and_b32 v27, 7, v25
    v_xor_b32 v26, v26, v27
    v_lshlrev_b32 v26, 4, v26
    v_lshl_add_u32 v26, v25, 7, v26
    v_add_u32 v22, 65536, v26
    s_lshl_b32 s3, s24, 10
    s_add_u32 s3, s3, 65536
    v_lshlrev_b32 v26, 4, v0
    v_add_u32 v23, s3, v26
    s_lshl_b32 s3, s24, 3
    v_lshrrev_b32 v25, 3, v0
    v_add_u32 v25, s3, v25
    v_and_b32 v26, 7, v25
    v_and_b32 v27, 7, v0
    v_xor_b32 v26, v26, v27
    v_lshlrev_b32 v26, 4, v26
    v_lshl_add_u32 v26, v25, 14, v26
    v_add_u32 v26, s30, v26
    v_cmp_gt_u32 vcc, s31, v25
    v_mov_b32 v24, 0x80000000
    s_nop 0
    v_cndmask_b32 v24, v24, v26, vcc
    v_and_b32 v25, 15, v0
    v_lshlrev_b32 v27, 14, v25
    v_bfe_u32 v26, v0, 4, 1
    v_lshl_add_u32 v27, v26, 4, v27
    v_lshrrev_b32 v26, 5, v0
    v_lshl_add_u32 v27, v26, 3, v27
    v_add_u32 v32, s40, v27
    v_add_u32 v27, 262144, v32
    v_add_u32 v25, 16, v25
    v_cmp_gt_u32 vcc, s31, v25
    v_mov_b32 v33, 0x80000000
    v_mov_b32 v34, 0x80000000
    v_cndmask_b32 v33, v33, v27, vcc
    v_lshlrev_b32 v36, 2, v0
    v_add_u32 v36, 73728, v36
    v_mov_b32 v37, 0x100
    s_mov_b32 s32, 0xc038aa3b
    s_mov_b32 s33, 0xbfb8aa3b
    s_mov_b32 s34, 0x42000000
    s_mov_b32 s36, -1024
    s_mov_b64 vcc, -1
    s_cmp_eq_u32 s24, 0
    s_cbranch_scc1 L_stub0
    s_cmp_eq_u32 s24, 1
    s_cbranch_scc1 L_stub1
    s_cmp_eq_u32 s24, 2
    s_cbranch_scc1 L_stub2
    s_cmp_eq_u32 s24, 3
    s_cbranch_scc1 L_stub3
L_tour_ret:
    s_mov_b64 vcc, 0
    s_waitcnt vmcnt(8)
    s_add_u32 m0, s39, 4096
    s_xor_b32 s35, s9, 128
    buffer_load_dwordx4 v9, s[12:15], s35 offen offset:0  lds
    buffer_load_dwordx4 v10, s[12:15], s35 offen offset:1024  lds
    buffer_load_dwordx4 v11, s[12:15], s35 offen offset:2048  lds
    buffer_load_dwordx4 v12, s[12:15], s35 offen offset:3072  lds
    s_barrier
    ds_read_b64_tr_b16 a[0:1], v17 offset:0
    ds_read_b64_tr_b16 a[2:3], v17 offset:256
    ds_read_b64_tr_b16 a[4:5], v18 offset:0
    ds_read_b64_tr_b16 a[6:7], v18 offset:256
    ds_read_b64_tr_b16 a[8:9], v17 offset:8192
    ds_read_b64_tr_b16 a[10:11], v17 offset:8448
    ds_read_b64_tr_b16 a[12:13], v18 offset:8192
    ds_read_b64_tr_b16 a[14:15], v18 offset:8448
    s_waitcnt vmcnt(8) lgkmcnt(0)
    s_add_u32 m0, s38, 98304
    s_xor_b32 s37, s8, 131072
    buffer_load_dwordx4 v5, s[16:19], s37 offen offset:0  lds
    buffer_load_dwordx4 v6, s[16:19], s37 offen offset:1024  lds
    buffer_load_dwordx4 v7, s[16:19], s37 offen offset:2048  lds
    buffer_load_dwordx4 v8, s[16:19], s37 offen offset:3072  lds
    s_barrier
    ds_read_b128 v[112:115], v40 offset:0
    ds_read_b128 v[116:119], v40 offset:2048
    ds_read_b128 v[120:123], v41 offset:0
    ds_read_b128 v[124:127], v41 offset:2048
    ds_read_b128 v[128:131], v40 offset:16384
    ds_read_b128 v[132:135], v40 offset:18432
    ds_read_b128 v[136:139], v41 offset:16384
    ds_read_b128 v[140:143], v41 offset:18432
    ds_read_b128 v[192:195], v40 offset:32768
    ds_read_b128 v[196:199], v40 offset:34816
    ds_read_b128 v[200:203], v41 offset:32768
    ds_read_b128 v[204:207], v41 offset:34816
    ds_read_b128 a[192:195], v40 offset:49152
    ds_read_b128 a[196:199], v40 offset:51200
    ds_read_b128 a[200:203], v41 offset:49152
    s_waitcnt lgkmcnt(14)
    v_mfma_f32_16x16x32_bf16 v[80:83], a[0:3], v[112:115], 0
    ds_read_b128 a[204:207], v41 offset:51200
    s_waitcnt lgkmcnt(13)
    v_mfma_f32_16x16x32_bf16 v[80:83], a[8:11], v[120:123], v[80:83]
    v_mfma_f32_16x16x32_bf16 v[84:87], a[0:3], v[116:119], 0
    s_waitcnt lgkmcnt(12)
    v_mfma_f32_16x16x32_bf16 v[84:87], a[8:11], v[124:127], v[84:87]
    v_mfma_f32_16x16x32_bf16 v[88:91], a[4:7], v[112:115], 0
    v_mfma_f32_16x16x32_bf16 v[88:91], a[12:15], v[120:123], v[88:91]
    v_mfma_f32_16x16x32_bf16 v[92:95], a[4:7], v[116:119], 0
    v_mfma_f32_16x16x32_bf16 v[92:95], a[12:15], v[124:127], v[92:95]
    s_waitcnt lgkmcnt(11)
    v_mfma_f32_16x16x32_bf16 v[96:99], a[0:3], v[128:131], 0
    s_waitcnt lgkmcnt(9)
    v_mfma_f32_16x16x32_bf16 v[96:99], a[8:11], v[136:139], v[96:99]
    v_mfma_f32_16x16x32_bf16 v[100:103], a[0:3], v[132:135], 0
    s_waitcnt lgkmcnt(8)
    v_mfma_f32_16x16x32_bf16 v[100:103], a[8:11], v[140:143], v[100:103]
    v_mfma_f32_16x16x32_bf16 v[104:107], a[4:7], v[128:131], 0
    v_mfma_f32_16x16x32_bf16 v[104:107], a[12:15], v[136:139], v[104:107]
    v_mfma_f32_16x16x32_bf16 v[108:111], a[4:7], v[132:135], 0
    v_mfma_f32_16x16x32_bf16 v[108:111], a[12:15], v[140:143], v[108:111]
    s_waitcnt vmcnt(8)
    s_waitcnt lgkmcnt(7)
    v_mfma_f32_16x16x32_bf16 v[48:51], a[0:3], v[192:195], 0
    s_add_u32 m0, s39, 8192
    s_xor_b32 s35, s9, 256
    s_waitcnt lgkmcnt(5)
    v_mfma_f32_16x16x32_bf16 v[48:51], a[8:11], v[200:203], v[48:51]
    buffer_load_dwordx4 v9, s[12:15], s35 offen offset:0  lds
    v_mfma_f32_16x16x32_bf16 v[52:55], a[0:3], v[196:199], 0
    s_waitcnt lgkmcnt(4)
    v_mfma_f32_16x16x32_bf16 v[52:55], a[8:11], v[204:207], v[52:55]
    v_mfma_f32_16x16x32_bf16 v[56:59], a[4:7], v[192:195], 0
    v_mfma_f32_16x16x32_bf16 v[56:59], a[12:15], v[200:203], v[56:59]
    buffer_load_dwordx4 v10, s[12:15], s35 offen offset:1024  lds
    s_waitcnt vmcnt(6)
    s_barrier
    v_mfma_f32_16x16x32_bf16 v[60:63], a[4:7], v[196:199], 0
    ds_read_b64_tr_b16 a[16:17], v17 offset:16384
    ds_read_b64_tr_b16 a[18:19], v17 offset:16640
    v_mfma_f32_16x16x32_bf16 v[60:63], a[12:15], v[204:207], v[60:63]
    ds_read_b64_tr_b16 a[20:21], v18 offset:16384
    ds_read_b64_tr_b16 a[22:23], v18 offset:16640
    s_waitcnt lgkmcnt(7)
    v_mfma_f32_16x16x32_bf16 v[64:67], a[0:3], a[192:195], 0
    ds_read_b64_tr_b16 a[24:25], v17 offset:24576
    ds_read_b64_tr_b16 a[26:27], v17 offset:24832
    s_waitcnt lgkmcnt(7)
    v_mfma_f32_16x16x32_bf16 v[64:67], a[8:11], a[200:203], v[64:67]
    buffer_load_dwordx4 v11, s[12:15], s35 offen offset:2048  lds
    v_mfma_f32_16x16x32_bf16 v[68:71], a[0:3], a[196:199], 0
    ds_read_b64_tr_b16 a[28:29], v18 offset:24576
    ds_read_b64_tr_b16 a[30:31], v18 offset:24832
    s_waitcnt lgkmcnt(8)
    v_mfma_f32_16x16x32_bf16 v[68:71], a[8:11], a[204:207], v[68:71]
    ds_read_b128 v[112:115], v40 offset:4096
    ds_read_b128 v[116:119], v40 offset:6144
    v_mfma_f32_16x16x32_bf16 v[72:75], a[4:7], a[192:195], 0
    ds_read_b128 v[120:123], v41 offset:4096
    ds_read_b128 v[124:127], v41 offset:6144
    v_mfma_f32_16x16x32_bf16 v[72:75], a[12:15], a[200:203], v[72:75]
    buffer_load_dwordx4 v12, s[12:15], s35 offen offset:3072  lds
    v_mfma_f32_16x16x32_bf16 v[76:79], a[4:7], a[196:199], 0
    s_add_u32 m0, s38, 114688
    ds_read_b128 v[144:147], v40 offset:20480
    v_mfma_f32_16x16x32_bf16 v[76:79], a[12:15], a[204:207], v[76:79]
    s_xor_b32 s37, s8, 196608
    ds_read_b128 v[148:151], v40 offset:22528
    s_waitcnt lgkmcnt(5)
    v_mfma_f32_16x16x32_bf16 v[80:83], a[16:19], v[112:115], v[80:83]
    ds_read_b128 v[152:155], v41 offset:20480
    ds_read_b128 v[156:159], v41 offset:22528
    s_waitcnt lgkmcnt(5)
    v_mfma_f32_16x16x32_bf16 v[80:83], a[24:27], v[120:123], v[80:83]
    buffer_load_dwordx4 v5, s[16:19], s37 offen offset:0  lds
    v_mfma_f32_16x16x32_bf16 v[84:87], a[16:19], v[116:119], v[84:87]
    ds_read_b128 v[208:211], v40 offset:36864
    ds_read_b128 v[212:215], v40 offset:38912
    s_waitcnt lgkmcnt(6)
    v_mfma_f32_16x16x32_bf16 v[84:87], a[24:27], v[124:127], v[84:87]
    ds_read_b128 v[216:219], v41 offset:36864
    ds_read_b128 v[220:223], v41 offset:38912
    v_mfma_f32_16x16x32_bf16 v[88:91], a[20:23], v[112:115], v[88:91]
    ds_read_b128 a[208:211], v40 offset:53248
    ds_read_b128 a[212:215], v40 offset:55296
    v_mfma_f32_16x16x32_bf16 v[88:91], a[28:31], v[120:123], v[88:91]
    buffer_load_dwordx4 v6, s[16:19], s37 offen offset:1024  lds
    v_mfma_f32_16x16x32_bf16 v[92:95], a[20:23], v[116:119], v[92:95]
    ds_read_b128 a[216:219], v41 offset:53248
    ds_read_b128 a[220:223], v41 offset:55296
    v_mfma_f32_16x16x32_bf16 v[92:95], a[28:31], v[124:127], v[92:95]
    s_waitcnt lgkmcnt(11)
    v_mfma_f32_16x16x32_bf16 v[96:99], a[16:19], v[144:147], v[96:99]
    s_waitcnt lgkmcnt(9)
    v_mfma_f32_16x16x32_bf16 v[96:99], a[24:27], v[152:155], v[96:99]
    buffer_load_dwordx4 v7, s[16:19], s37 offen offset:2048  lds
    v_mfma_f32_16x16x32_bf16 v[100:103], a[16:19], v[148:151], v[100:103]
    s_waitcnt lgkmcnt(8)
    v_mfma_f32_16x16x32_bf16 v[100:103], a[24:27], v[156:159], v[100:103]
    s_waitcnt vmcnt(7)
    v_mfma_f32_16x16x32_bf16 v[104:107], a[20:23], v[144:147], v[104:107]
    v_mfma_f32_16x16x32_bf16 v[104:107], a[28:31], v[152:155], v[104:107]
    buffer_load_dwordx4 v8, s[16:19], s37 offen offset:3072  lds
    v_mfma_f32_16x16x32_bf16 v[108:111], a[20:23], v[148:151], v[108:111]
    s_add_u32 m0, s39, 12288
    s_xor_b32 s35, s9, 384
    v_mfma_f32_16x16x32_bf16 v[108:111], a[28:31], v[156:159], v[108:111]
    s_waitcnt lgkmcnt(7)
    v_mfma_f32_16x16x32_bf16 v[48:51], a[16:19], v[208:211], v[48:51]
    s_waitcnt lgkmcnt(5)
    v_mfma_f32_16x16x32_bf16 v[48:51], a[24:27], v[216:219], v[48:51]
    buffer_load_dwordx4 v9, s[12:15], s35 offen offset:0  lds
    v_mfma_f32_16x16x32_bf16 v[52:55], a[16:19], v[212:215], v[52:55]
    s_waitcnt lgkmcnt(4)
    v_mfma_f32_16x16x32_bf16 v[52:55], a[24:27], v[220:223], v[52:55]
    s_waitcnt vmcnt(5)
    s_barrier
    v_mfma_f32_16x16x32_bf16 v[56:59], a[20:23], v[208:211], v[56:59]
    ds_read_b64_tr_b16 a[32:33], v17 offset:32768
    ds_read_b64_tr_b16 a[34:35], v17 offset:33024
    v_mfma_f32_16x16x32_bf16 v[56:59], a[28:31], v[216:219], v[56:59]
    buffer_load_dwordx4 v10, s[12:15], s35 offen offset:1024  lds
    v_mfma_f32_16x16x32_bf16 v[60:63], a[20:23], v[212:215], v[60:63]
    ds_read_b64_tr_b16 a[36:37], v18 offset:32768
    ds_read_b64_tr_b16 a[38:39], v18 offset:33024
    v_mfma_f32_16x16x32_bf16 v[60:63], a[28:31], v[220:223], v[60:63]
    ds_read_b64_tr_b16 a[40:41], v17 offset:40960
    ds_read_b64_tr_b16 a[42:43], v17 offset:41216
    s_waitcnt lgkmcnt(9)
    v_mfma_f32_16x16x32_bf16 v[64:67], a[16:19], a[208:211], v[64:67]
    ds_read_b64_tr_b16 a[44:45], v18 offset:40960
    ds_read_b64_tr_b16 a[46:47], v18 offset:41216
    s_waitcnt lgkmcnt(9)
    v_mfma_f32_16x16x32_bf16 v[64:67], a[24:27], a[216:219], v[64:67]
    buffer_load_dwordx4 v11, s[12:15], s35 offen offset:2048  lds
    v_mfma_f32_16x16x32_bf16 v[68:71], a[16:19], a[212:215], v[68:71]
    ds_read_b128 v[112:115], v40 offset:8192
    ds_read_b128 v[116:119], v40 offset:10240
    s_waitcnt lgkmcnt(10)
    v_mfma_f32_16x16x32_bf16 v[68:71], a[24:27], a[220:223], v[68:71]
    ds_read_b128 v[120:123], v41 offset:8192
    ds_read_b128 v[124:127], v41 offset:10240
    v_mfma_f32_16x16x32_bf16 v[72:75], a[20:23], a[208:211], v[72:75]
    ds_read_b128 v[160:163], v40 offset:24576
    ds_read_b128 v[164:167], v40 offset:26624
    v_mfma_f32_16x16x32_bf16 v[72:75], a[28:31], a[216:219], v[72:75]
    buffer_load_dwordx4 v12, s[12:15], s35 offen offset:3072  lds
    v_mfma_f32_16x16x32_bf16 v[76:79], a[20:23], a[212:215], v[76:79]
    s_add_u32 m0, s38, 131072
    ds_read_b128 v[168:171], v41 offset:24576
    v_mfma_f32_16x16x32_bf16 v[76:79], a[28:31], a[220:223], v[76:79]
    s_xor_b32 s37, s8, 262144
    s_waitcnt lgkmcnt(14)
    ds_read_b128 v[172:175], v41 offset:26624
    s_waitcnt lgkmcnt(7)
    v_mfma_f32_16x16x32_bf16 v[80:83], a[32:35], v[112:115], v[80:83]
    ds_read_b128 v[224:227], v40 offset:40960
    ds_read_b128 v[228:231], v40 offset:43008
    s_waitcnt lgkmcnt(7)
    v_mfma_f32_16x16x32_bf16 v[80:83], a[40:43], v[120:123], v[80:83]
    buffer_load_dwordx4 v5, s[16:19], s37 offen offset:0  lds
    v_mfma_f32_16x16x32_bf16 v[84:87], a[32:35], v[116:119], v[84:87]
    ds_read_b128 v[232:235], v41 offset:40960
    ds_read_b128 v[236:239], v41 offset:43008
    s_waitcnt lgkmcnt(8)
    v_mfma_f32_16x16x32_bf16 v[84:87], a[40:43], v[124:127], v[84:87]
    ds_read_b128 a[224:227], v40 offset:57344
    ds_read_b128 a[228:231], v40 offset:59392
    v_mfma_f32_16x16x32_bf16 v[88:91], a[36:39], v[112:115], v[88:91]
    ds_read_b128 a[232:235], v41 offset:57344
    ds_read_b128 a[236:239], v41 offset:59392
    v_mfma_f32_16x16x32_bf16 v[88:91], a[44:47], v[120:123], v[88:91]
    buffer_load_dwordx4 v6, s[16:19], s37 offen offset:1024  lds
    v_mfma_f32_16x16x32_bf16 v[92:95], a[36:39], v[116:119], v[92:95]
    v_mfma_f32_16x16x32_bf16 v[92:95], a[44:47], v[124:127], v[92:95]
    s_waitcnt lgkmcnt(11)
    v_mfma_f32_16x16x32_bf16 v[96:99], a[32:35], v[160:163], v[96:99]
    s_waitcnt lgkmcnt(9)
    v_mfma_f32_16x16x32_bf16 v[96:99], a[40:43], v[168:171], v[96:99]
    buffer_load_dwordx4 v7, s[16:19], s37 offen offset:2048  lds
    v_mfma_f32_16x16x32_bf16 v[100:103], a[32:35], v[164:167], v[100:103]
    s_waitcnt lgkmcnt(8)
    v_mfma_f32_16x16x32_bf16 v[100:103], a[40:43], v[172:175], v[100:103]
    s_waitcnt vmcnt(7)
    v_mfma_f32_16x16x32_bf16 v[104:107], a[36:39], v[160:163], v[104:107]
    v_mfma_f32_16x16x32_bf16 v[104:107], a[44:47], v[168:171], v[104:107]
    buffer_load_dwordx4 v8, s[16:19], s37 offen offset:3072  lds
    v_mfma_f32_16x16x32_bf16 v[108:111], a[36:39], v[164:167], v[108:111]
    s_add_u32 m0, s38, 147456
    s_xor_b32 s37, s8, 524288
    v_mfma_f32_16x16x32_bf16 v[108:111], a[44:47], v[172:175], v[108:111]
    s_waitcnt lgkmcnt(7)
    v_mfma_f32_16x16x32_bf16 v[48:51], a[32:35], v[224:227], v[48:51]
    s_waitcnt lgkmcnt(5)
    v_mfma_f32_16x16x32_bf16 v[48:51], a[40:43], v[232:235], v[48:51]
    buffer_load_dwordx4 v5, s[16:19], s37 offen offset:0  lds
    v_mfma_f32_16x16x32_bf16 v[52:55], a[32:35], v[228:231], v[52:55]
    s_waitcnt lgkmcnt(4)
    v_mfma_f32_16x16x32_bf16 v[52:55], a[40:43], v[236:239], v[52:55]
    s_waitcnt vmcnt(5)
    s_barrier
    v_mfma_f32_16x16x32_bf16 v[56:59], a[36:39], v[224:227], v[56:59]
    ds_read_b64_tr_b16 a[48:49], v17 offset:49152
    ds_read_b64_tr_b16 a[50:51], v17 offset:49408
    v_mfma_f32_16x16x32_bf16 v[56:59], a[44:47], v[232:235], v[56:59]
    buffer_load_dwordx4 v6, s[16:19], s37 offen offset:1024  lds
    v_mfma_f32_16x16x32_bf16 v[60:63], a[36:39], v[228:231], v[60:63]
    ds_read_b64_tr_b16 a[52:53], v18 offset:49152
    ds_read_b64_tr_b16 a[54:55], v18 offset:49408
    v_mfma_f32_16x16x32_bf16 v[60:63], a[44:47], v[236:239], v[60:63]
    ds_read_b64_tr_b16 a[56:57], v17 offset:57344
    ds_read_b64_tr_b16 a[58:59], v17 offset:57600
    s_waitcnt lgkmcnt(9)
    v_mfma_f32_16x16x32_bf16 v[64:67], a[32:35], a[224:227], v[64:67]
    ds_read_b64_tr_b16 a[60:61], v18 offset:57344
    ds_read_b64_tr_b16 a[62:63], v18 offset:57600
    s_waitcnt lgkmcnt(9)
    v_mfma_f32_16x16x32_bf16 v[64:67], a[40:43], a[232:235], v[64:67]
    buffer_load_dwordx4 v7, s[16:19], s37 offen offset:2048  lds
    v_mfma_f32_16x16x32_bf16 v[68:71], a[32:35], a[228:231], v[68:71]
    ds_read_b128 v[112:115], v40 offset:12288
    ds_read_b128 v[116:119], v40 offset:14336
    s_waitcnt lgkmcnt(10)
    v_mfma_f32_16x16x32_bf16 v[68:71], a[40:43], a[236:239], v[68:71]
    ds_read_b128 v[120:123], v41 offset:12288
    ds_read_b128 v[124:127], v41 offset:14336
    v_mfma_f32_16x16x32_bf16 v[72:75], a[36:39], a[224:227], v[72:75]
    ds_read_b128 v[176:179], v40 offset:28672
    ds_read_b128 v[180:183], v40 offset:30720
    v_mfma_f32_16x16x32_bf16 v[72:75], a[44:47], a[232:235], v[72:75]
    buffer_load_dwordx4 v8, s[16:19], s37 offen offset:3072  lds
    v_mfma_f32_16x16x32_bf16 v[76:79], a[36:39], a[228:231], v[76:79]
    s_add_u32 m0, s38, 65536
    ds_read_b128 v[184:187], v41 offset:28672
    v_mfma_f32_16x16x32_bf16 v[76:79], a[44:47], a[236:239], v[76:79]
    s_xor_b32 s37, s8, 327680
    s_waitcnt lgkmcnt(14)
    ds_read_b128 v[188:191], v41 offset:30720
    s_waitcnt lgkmcnt(7)
    v_mfma_f32_16x16x32_bf16 v[80:83], a[48:51], v[112:115], v[80:83]
    ds_read_b128 v[240:243], v40 offset:45056
    ds_read_b128 v[244:247], v40 offset:47104
    s_waitcnt lgkmcnt(7)
    v_mfma_f32_16x16x32_bf16 v[80:83], a[56:59], v[120:123], v[80:83]
    buffer_load_dwordx4 v5, s[16:19], s37 offen offset:0  lds
    v_mfma_f32_16x16x32_bf16 v[84:87], a[48:51], v[116:119], v[84:87]
    ds_read_b128 v[248:251], v41 offset:45056
L_stub0:
    s_cbranch_vccnz L_tour_ret
    ds_read_b128 v[252:255], v41 offset:47104
    s_waitcnt lgkmcnt(8)
    v_mfma_f32_16x16x32_bf16 v[84:87], a[56:59], v[124:127], v[84:87]
    ds_read_b128 a[240:243], v40 offset:61440
    ds_read_b128 a[244:247], v40 offset:63488
    v_mfma_f32_16x16x32_bf16 v[88:91], a[52:55], v[112:115], v[88:91]
    ds_read_b128 a[248:251], v41 offset:61440
    ds_read_b128 a[252:255], v41 offset:63488
    v_mfma_f32_16x16x32_bf16 v[88:91], a[60:63], v[120:123], v[88:91]
    buffer_load_dwordx4 v6, s[16:19], s37 offen offset:1024  lds
    v_mfma_f32_16x16x32_bf16 v[92:95], a[52:55], v[116:119], v[92:95]
    v_mfma_f32_16x16x32_bf16 v[92:95], a[60:63], v[124:127], v[92:95]
    s_waitcnt lgkmcnt(11)
    v_mfma_f32_16x16x32_bf16 v[96:99], a[48:51], v[176:179], v[96:99]
    s_waitcnt lgkmcnt(9)
    v_mfma_f32_16x16x32_bf16 v[96:99], a[56:59], v[184:187], v[96:99]
    buffer_load_dwordx4 v7, s[16:19], s37 offen offset:2048  lds
    v_mfma_f32_16x16x32_bf16 v[100:103], a[48:51], v[180:183], v[100:103]
    s_waitcnt lgkmcnt(8)
    v_mfma_f32_16x16x32_bf16 v[100:103], a[56:59], v[188:191], v[100:103]
    v_mfma_f32_16x16x32_bf16 v[104:107], a[52:55], v[176:179], v[104:107]
    v_mfma_f32_16x16x32_bf16 v[104:107], a[60:63], v[184:187], v[104:107]
    buffer_load_dwordx4 v8, s[16:19], s37 offen offset:3072  lds
    v_mfma_f32_16x16x32_bf16 v[108:111], a[52:55], v[180:183], v[108:111]
    v_mfma_f32_16x16x32_bf16 v[108:111], a[60:63], v[188:191], v[108:111]
    s_waitcnt lgkmcnt(7)
    v_mfma_f32_16x16x32_bf16 v[48:51], a[48:51], v[240:243], v[48:51]
    s_waitcnt lgkmcnt(5)
    v_mfma_f32_16x16x32_bf16 v[48:51], a[56:59], v[248:251], v[48:51]
    v_mfma_f32_16x16x32_bf16 v[52:55], a[48:51], v[244:247], v[52:55]
    s_waitcnt lgkmcnt(4)
    v_mfma_f32_16x16x32_bf16 v[52:55], a[56:59], v[252:255], v[52:55]
    s_waitcnt vmcnt(8)
    s_barrier
    v_mfma_f32_16x16x32_bf16 v[56:59], a[52:55], v[240:243], v[56:59]
    s_add_u32 m0, s38, 81920
    ds_read_b64_tr_b16 a[64:65], v19 offset:0
    v_mfma_f32_16x16x32_bf16 v[56:59], a[60:63], v[248:251], v[56:59]
    s_xor_b32 s37, s8, 589824
    ds_read_b64_tr_b16 a[66:67], v19 offset:256
    v_mfma_f32_16x16x32_bf16 v[60:63], a[52:55], v[244:247], v[60:63]
    buffer_load_dwordx4 v5, s[16:19], s37 offen offset:0  lds
    v_mfma_f32_16x16x32_bf16 v[60:63], a[60:63], v[252:255], v[60:63]
    ds_read_b64_tr_b16 a[68:69], v20 offset:0
    ds_read_b64_tr_b16 a[70:71], v20 offset:256
    s_waitcnt lgkmcnt(7)
    v_mfma_f32_16x16x32_bf16 v[64:67], a[48:51], a[240:243], v[64:67]
    ds_read_b64_tr_b16 a[72:73], v19 offset:8192
    ds_read_b64_tr_b16 a[74:75], v19 offset:8448
    s_waitcnt lgkmcnt(7)
    v_mfma_f32_16x16x32_bf16 v[64:67], a[56:59], a[248:251], v[64:67]
    ds_read_b64_tr_b16 a[76:77], v20 offset:8192
    ds_read_b64_tr_b16 a[78:79], v20 offset:8448
    v_mfma_f32_16x16x32_bf16 v[68:71], a[48:51], a[244:247], v[68:71]
    buffer_load_dwordx4 v6, s[16:19], s37 offen offset:1024  lds
    s_waitcnt lgkmcnt(8)
    v_mfma_f32_16x16x32_bf16 v[68:71], a[56:59], a[252:255], v[68:71]
    v_mfma_f32_16x16x32_bf16 v[72:75], a[52:55], a[240:243], v[72:75]
    v_mfma_f32_16x16x32_bf16 v[72:75], a[60:63], a[248:251], v[72:75]
    v_mfma_f32_16x16x32_bf16 v[76:79], a[52:55], a[244:247], v[76:79]
    buffer_load_dwordx4 v7, s[16:19], s37 offen offset:2048  lds
    v_mfma_f32_16x16x32_bf16 v[76:79], a[60:63], a[252:255], v[76:79]
    s_waitcnt lgkmcnt(6)
    v_mfma_f32_16x16x32_bf16 v[80:83], a[64:67], v[128:131], v[80:83]
    s_waitcnt lgkmcnt(2)
    v_mfma_f32_16x16x32_bf16 v[80:83], a[72:75], v[136:139], v[80:83]
    v_mfma_f32_16x16x32_bf16 v[84:87], a[64:67], v[132:135], v[84:87]
    buffer_load_dwordx4 v8, s[16:19], s37 offen offset:3072  lds
    v_mfma_f32_16x16x32_bf16 v[84:87], a[72:75], v[140:143], v[84:87]
    v_mfma_f32_16x16x32_bf16 v[88:91], a[68:71], v[128:131], v[88:91]
    s_waitcnt lgkmcnt(0)
    v_mfma_f32_16x16x32_bf16 v[88:91], a[76:79], v[136:139], v[88:91]
    v_mfma_f32_16x16x32_bf16 v[92:95], a[68:71], v[132:135], v[92:95]
    v_mfma_f32_16x16x32_bf16 v[92:95], a[76:79], v[140:143], v[92:95]
    v_mfma_f32_16x16x32_bf16 v[96:99], a[64:67], v[192:195], v[96:99]
    v_mfma_f32_16x16x32_bf16 v[96:99], a[72:75], v[200:203], v[96:99]
    v_mfma_f32_16x16x32_bf16 v[100:103], a[64:67], v[196:199], v[100:103]
    v_mfma_f32_16x16x32_bf16 v[100:103], a[72:75], v[204:207], v[100:103]
    s_waitcnt vmcnt(8)
    s_barrier
    v_mfma_f32_16x16x32_bf16 v[104:107], a[68:71], v[192:195], v[104:107]
    s_add_u32 m0, s38, 0
    ds_read_b64_tr_b16 a[128:129], v19 offset:16384
    v_mfma_f32_16x16x32_bf16 v[104:107], a[76:79], v[200:203], v[104:107]
    s_mov_b32 s35, 2048
    ds_read_b64_tr_b16 a[130:131], v19 offset:16640
    v_mfma_f32_16x16x32_bf16 v[108:111], a[68:71], v[196:199], v[108:111]
    buffer_load_dwordx4 v1, s[12:15], s35 offen offset:0  lds
    v_mfma_f32_16x16x32_bf16 v[108:111], a[76:79], v[204:207], v[108:111]
    ds_read_b64_tr_b16 a[132:133], v20 offset:16384
    ds_read_b64_tr_b16 a[134:135], v20 offset:16640
    v_mfma_f32_16x16x32_bf16 v[48:51], a[64:67], a[192:195], v[48:51]
    ds_read_b64_tr_b16 a[136:137], v19 offset:24576
    ds_read_b64_tr_b16 a[138:139], v19 offset:24832
    v_mfma_f32_16x16x32_bf16 v[48:51], a[72:75], a[200:203], v[48:51]
    ds_read_b64_tr_b16 a[140:141], v20 offset:24576
    ds_read_b64_tr_b16 a[142:143], v20 offset:24832
    v_mfma_f32_16x16x32_bf16 v[52:55], a[64:67], a[196:199], v[52:55]
    buffer_load_dwordx4 v2, s[12:15], s35 offen offset:1024  lds
    v_mfma_f32_16x16x32_bf16 v[52:55], a[72:75], a[204:207], v[52:55]
    v_mfma_f32_16x16x32_bf16 v[56:59], a[68:71], a[192:195], v[56:59]
    v_mfma_f32_16x16x32_bf16 v[56:59], a[76:79], a[200:203], v[56:59]
    v_mfma_f32_16x16x32_bf16 v[60:63], a[68:71], a[196:199], v[60:63]
    buffer_load_dwordx4 v3, s[12:15], s35 offen offset:2048  lds
    v_mfma_f32_16x16x32_bf16 v[60:63], a[76:79], a[204:207], v[60:63]
    s_waitcnt lgkmcnt(6)
    v_mfma_f32_16x16x32_bf16 v[80:83], a[128:131], v[192:195], v[80:83]
    s_waitcnt lgkmcnt(2)
    v_mfma_f32_16x16x32_bf16 v[80:83], a[136:139], v[200:203], v[80:83]
    v_mfma_f32_16x16x32_bf16 v[84:87], a[128:131], v[196:199], v[84:87]
    buffer_load_dwordx4 v4, s[12:15], s35 offen offset:3072  lds
    v_mfma_f32_16x16x32_bf16 v[84:87], a[136:139], v[204:207], v[84:87]
    s_waitcnt vmcnt(8)
    s_barrier
    v_mfma_f32_16x16x32_bf16 v[88:91], a[132:135], v[192:195], v[88:91]
    s_add_u32 m0, s38, 98304
    ds_read_b64_tr_b16 a[80:81], v17 offset:0
    s_waitcnt lgkmcnt(1)
    v_mfma_f32_16x16x32_bf16 v[88:91], a[140:143], v[200:203], v[88:91]
    s_xor_b32 s37, s8, 393216
    ds_read_b64_tr_b16 a[82:83], v17 offset:256
    v_mfma_f32_16x16x32_bf16 v[92:95], a[132:135], v[196:199], v[92:95]
    buffer_load_dwordx4 v5, s[16:19], s37 offen offset:0  lds
    v_mfma_f32_16x16x32_bf16 v[92:95], a[140:143], v[204:207], v[92:95]
    ds_read_b64_tr_b16 a[84:85], v18 offset:0
    ds_read_b64_tr_b16 a[86:87], v18 offset:256
    v_mfma_f32_16x16x32_bf16 v[96:99], a[128:131], a[192:195], v[96:99]
    ds_read_b64_tr_b16 a[88:89], v17 offset:8192
    ds_read_b64_tr_b16 a[90:91], v17 offset:8448
    v_mfma_f32_16x16x32_bf16 v[96:99], a[136:139], a[200:203], v[96:99]
    ds_read_b64_tr_b16 a[92:93], v18 offset:8192
    ds_read_b64_tr_b16 a[94:95], v18 offset:8448
    v_mfma_f32_16x16x32_bf16 v[100:103], a[128:131], a[196:199], v[100:103]
    buffer_load_dwordx4 v6, s[16:19], s37 offen offset:1024  lds
    v_mfma_f32_16x16x32_bf16 v[100:103], a[136:139], a[204:207], v[100:103]
    v_mfma_f32_16x16x32_bf16 v[104:107], a[132:135], a[192:195], v[104:107]
    v_mfma_f32_16x16x32_bf16 v[104:107], a[140:143], a[200:203], v[104:107]
    v_mfma_f32_16x16x32_bf16 v[108:111], a[132:135], a[196:199], v[108:111]
    buffer_load_dwordx4 v7, s[16:19], s37 offen offset:2048  lds
    v_mfma_f32_16x16x32_bf16 v[108:111], a[140:143], a[204:207], v[108:111]
    s_waitcnt lgkmcnt(6)
    v_mfma_f32_16x16x32_bf16 v[80:83], a[80:83], v[144:147], v[80:83]
    s_waitcnt lgkmcnt(2)
    v_mfma_f32_16x16x32_bf16 v[80:83], a[88:91], v[152:155], v[80:83]
    v_mfma_f32_16x16x32_bf16 v[84:87], a[80:83], v[148:151], v[84:87]
    buffer_load_dwordx4 v8, s[16:19], s37 offen offset:3072  lds
    v_mfma_f32_16x16x32_bf16 v[84:87], a[88:91], v[156:159], v[84:87]
    v_mfma_f32_16x16x32_bf16 v[88:91], a[84:87], v[144:147], v[88:91]
    s_waitcnt lgkmcnt(0)
    v_mfma_f32_16x16x32_bf16 v[88:91], a[92:95], v[152:155], v[88:91]
    v_mfma_f32_16x16x32_bf16 v[92:95], a[84:87], v[148:151], v[92:95]
    v_mfma_f32_16x16x32_bf16 v[92:95], a[92:95], v[156:159], v[92:95]
    v_mfma_f32_16x16x32_bf16 v[96:99], a[80:83], v[208:211], v[96:99]
    v_mfma_f32_16x16x32_bf16 v[96:99], a[88:91], v[216:219], v[96:99]
    v_mfma_f32_16x16x32_bf16 v[100:103], a[80:83], v[212:215], v[100:103]
    v_mfma_f32_16x16x32_bf16 v[100:103], a[88:91], v[220:223], v[100:103]
    s_waitcnt vmcnt(8)
    s_barrier
    v_mov_b32 v38, 0x1000
    ds_write_b32 v36, v38
    v_mfma_f32_16x16x32_bf16 v[104:107], a[84:87], v[208:211], v[104:107]
    s_add_u32 m0, s38, 114688
    ds_read_b64_tr_b16 a[144:145], v17 offset:16384
    v_mfma_f32_16x16x32_bf16 v[104:107], a[92:95], v[216:219], v[104:107]
    s_xor_b32 s37, s8, 655360
    ds_read_b64_tr_b16 a[146:147], v17 offset:16640
    v_mfma_f32_16x16x32_bf16 v[108:111], a[84:87], v[212:215], v[108:111]
    buffer_load_dwordx4 v5, s[16:19], s37 offen offset:0  lds
    v_mfma_f32_16x16x32_bf16 v[108:111], a[92:95], v[220:223], v[108:111]
    ds_read_b64_tr_b16 a[148:149], v18 offset:16384
    ds_read_b64_tr_b16 a[150:151], v18 offset:16640
    v_mfma_f32_16x16x32_bf16 v[48:51], a[80:83], a[208:211], v[48:51]
    ds_read_b64_tr_b16 a[152:153], v17 offset:24576
    ds_read_b64_tr_b16 a[154:155], v17 offset:24832
    v_mfma_f32_16x16x32_bf16 v[48:51], a[88:91], a[216:219], v[48:51]
    ds_read_b64_tr_b16 a[156:157], v18 offset:24576
    ds_read_b64_tr_b16 a[158:159], v18 offset:24832
    v_mfma_f32_16x16x32_bf16 v[52:55], a[80:83], a[212:215], v[52:55]
    buffer_load_dwordx4 v6, s[16:19], s37 offen offset:1024  lds
    v_mfma_f32_16x16x32_bf16 v[52:55], a[88:91], a[220:223], v[52:55]
    v_mfma_f32_16x16x32_bf16 v[56:59], a[84:87], a[208:211], v[56:59]
    v_mfma_f32_16x16x32_bf16 v[56:59], a[92:95], a[216:219], v[56:59]
    v_mfma_f32_16x16x32_bf16 v[60:63], a[84:87], a[212:215], v[60:63]
    buffer_load_dwordx4 v7, s[16:19], s37 offen offset:2048  lds
    v_mfma_f32_16x16x32_bf16 v[60:63], a[92:95], a[220:223], v[60:63]
    s_waitcnt vmcnt(7)
    s_waitcnt lgkmcnt(6)
    v_mfma_f32_16x16x32_bf16 v[80:83], a[144:147], v[208:211], v[80:83]
    s_waitcnt lgkmcnt(2)
    v_mfma_f32_16x16x32_bf16 v[80:83], a[152:155], v[216:219], v[80:83]
    v_mfma_f32_16x16x32_bf16 v[84:87], a[144:147], v[212:215], v[84:87]
    buffer_load_dwordx4 v8, s[16:19], s37 offen offset:3072  lds
    v_mfma_f32_16x16x32_bf16 v[84:87], a[152:155], v[220:223], v[84:87]
    s_add_u32 m0, s38, 131072
    s_xor_b32 s37, s8, 458752
    v_mfma_f32_16x16x32_bf16 v[88:91], a[148:151], v[208:211], v[88:91]
    s_waitcnt lgkmcnt(0)
    v_mfma_f32_16x16x32_bf16 v[88:91], a[156:159], v[216:219], v[88:91]
    s_waitcnt vmcnt(4)
    s_barrier
    v_mfma_f32_16x16x32_bf16 v[92:95], a[148:151], v[212:215], v[92:95]
    buffer_load_dwordx4 v5, s[16:19], s37 offen offset:0  lds
    v_mfma_f32_16x16x32_bf16 v[92:95], a[156:159], v[220:223], v[92:95]
    ds_read_b64_tr_b16 a[96:97], v17 offset:32768
    ds_read_b64_tr_b16 a[98:99], v17 offset:33024
    v_mfma_f32_16x16x32_bf16 v[96:99], a[144:147], a[208:211], v[96:99]
    ds_read_b64_tr_b16 a[100:101], v18 offset:32768
    ds_read_b64_tr_b16 a[102:103], v18 offset:33024
    v_mfma_f32_16x16x32_bf16 v[96:99], a[152:155], a[216:219], v[96:99]
    ds_read_b64_tr_b16 a[104:105], v17 offset:40960
    ds_read_b64_tr_b16 a[106:107], v17 offset:41216
    v_mfma_f32_16x16x32_bf16 v[100:103], a[144:147], a[212:215], v[100:103]
    buffer_load_dwordx4 v6, s[16:19], s37 offen offset:1024  lds
    v_mfma_f32_16x16x32_bf16 v[100:103], a[152:155], a[220:223], v[100:103]
    ds_read_b64_tr_b16 a[108:109], v18 offset:40960
    ds_read_b64_tr_b16 a[110:111], v18 offset:41216
    v_mfma_f32_16x16x32_bf16 v[104:107], a[148:151], a[208:211], v[104:107]
    ds_read_b128 v[128:131], v13 offset:0
    ds_read_b128 v[132:135], v13 offset:8192
    v_mfma_f32_16x16x32_bf16 v[104:107], a[156:159], a[216:219], v[104:107]
    ds_read_b128 v[136:139], v14 offset:0
    ds_read_b128 v[140:143], v14 offset:8192
    v_mfma_f32_16x16x32_bf16 v[108:111], a[148:151], a[212:215], v[108:111]
    buffer_load_dwordx4 v7, s[16:19], s37 offen offset:2048  lds
    v_mfma_f32_16x16x32_bf16 v[108:111], a[156:159], a[220:223], v[108:111]
    ds_read_b128 v[144:147], v15 offset:0
    ds_read_b128 v[148:151], v15 offset:8192
    s_waitcnt lgkmcnt(12)
    v_mfma_f32_16x16x32_bf16 v[80:83], a[96:99], v[160:163], v[80:83]
    ds_read_b128 v[152:155], v16 offset:0
    ds_read_b128 v[156:159], v16 offset:8192
    s_waitcnt lgkmcnt(10)
    v_mfma_f32_16x16x32_bf16 v[80:83], a[104:107], v[168:171], v[80:83]
    v_mfma_f32_16x16x32_bf16 v[84:87], a[96:99], v[164:167], v[84:87]
    buffer_load_dwordx4 v8, s[16:19], s37 offen offset:3072  lds
    v_mfma_f32_16x16x32_bf16 v[84:87], a[104:107], v[172:175], v[84:87]
    s_add_u32 m0, s38, 147456
    s_xor_b32 s37, s8, 720896
    v_mfma_f32_16x16x32_bf16 v[88:91], a[100:103], v[160:163], v[88:91]
    s_waitcnt lgkmcnt(8)
    v_mfma_f32_16x16x32_bf16 v[88:91], a[108:111], v[168:171], v[88:91]
    v_mfma_f32_16x16x32_bf16 v[92:95], a[100:103], v[164:167], v[92:95]
    buffer_load_dwordx4 v5, s[16:19], s37 offen offset:0  lds
    v_mfma_f32_16x16x32_bf16 v[92:95], a[108:111], v[172:175], v[92:95]
    v_mfma_f32_16x16x32_bf16 v[96:99], a[96:99], v[224:227], v[96:99]
    v_mfma_f32_16x16x32_bf16 v[96:99], a[104:107], v[232:235], v[96:99]
    ds_read_b128 v[160:163], v13 offset:256
    ds_read_b128 v[164:167], v13 offset:8448
    v_mfma_f32_16x16x32_bf16 v[100:103], a[96:99], v[228:231], v[100:103]
    buffer_load_dwordx4 v6, s[16:19], s37 offen offset:1024  lds
    v_mfma_f32_16x16x32_bf16 v[100:103], a[104:107], v[236:239], v[100:103]
    ds_read_b128 v[168:171], v14 offset:256
    ds_read_b128 v[172:175], v14 offset:8448
    s_waitcnt vmcnt(6)
    s_barrier
    v_mfma_f32_16x16x32_bf16 v[104:107], a[100:103], v[224:227], v[104:107]
    ds_read_b64_tr_b16 a[160:161], v17 offset:49152
    ds_read_b64_tr_b16 a[162:163], v17 offset:49408
    v_mfma_f32_16x16x32_bf16 v[104:107], a[108:111], v[232:235], v[104:107]
    ds_read_b64_tr_b16 a[164:165], v18 offset:49152
    s_waitcnt lgkmcnt(14)
    ds_read_b64_tr_b16 a[166:167], v18 offset:49408
    v_mfma_f32_16x16x32_bf16 v[108:111], a[100:103], v[228:231], v[108:111]
    buffer_load_dwordx4 v7, s[16:19], s37 offen offset:2048  lds
    v_mfma_f32_16x16x32_bf16 v[108:111], a[108:111], v[236:239], v[108:111]
    s_waitcnt lgkmcnt(14)
    ds_read_b64_tr_b16 a[168:169], v17 offset:57344
    s_waitcnt lgkmcnt(14)
    ds_read_b64_tr_b16 a[170:171], v17 offset:57600
    v_mfma_f32_16x16x32_bf16 v[48:51], a[96:99], a[224:227], v[48:51]
    s_waitcnt lgkmcnt(14)
    ds_read_b64_tr_b16 a[172:173], v18 offset:57344
    s_waitcnt lgkmcnt(14)
    ds_read_b64_tr_b16 a[174:175], v18 offset:57600
    v_mfma_f32_16x16x32_bf16 v[48:51], a[104:107], a[232:235], v[48:51]
    v_mfma_f32_16x16x32_bf16 v[52:55], a[96:99], a[228:231], v[52:55]
    buffer_load_dwordx4 v8, s[16:19], s37 offen offset:3072  lds
    v_mfma_f32_16x16x32_bf16 v[52:55], a[104:107], a[236:239], v[52:55]
    s_add_u32 m0, s38, 16384
    s_mov_b32 s35, 3072
    v_mfma_f32_16x16x32_bf16 v[56:59], a[100:103], a[224:227], v[56:59]
    v_mfma_f32_16x16x32_bf16 v[56:59], a[108:111], a[232:235], v[56:59]
    v_mfma_f32_16x16x32_bf16 v[60:63], a[100:103], a[228:231], v[60:63]
    buffer_load_dwordx4 v1, s[12:15], s35 offen offset:0  lds
    v_mfma_f32_16x16x32_bf16 v[60:63], a[108:111], a[236:239], v[60:63]
    s_waitcnt lgkmcnt(6)
    v_mfma_f32_16x16x32_bf16 v[80:83], a[160:163], v[224:227], v[80:83]
    s_waitcnt lgkmcnt(2)
    v_mfma_f32_16x16x32_bf16 v[80:83], a[168:171], v[232:235], v[80:83]
    v_mfma_f32_16x16x32_bf16 v[84:87], a[160:163], v[228:231], v[84:87]
    buffer_load_dwordx4 v2, s[12:15], s35 offen offset:1024  lds
    v_mfma_f32_16x16x32_bf16 v[84:87], a[168:171], v[236:239], v[84:87]
    v_mfma_f32_16x16x32_bf16 v[88:91], a[164:167], v[224:227], v[88:91]
    s_waitcnt lgkmcnt(0)
    v_mfma_f32_16x16x32_bf16 v[88:91], a[172:175], v[232:235], v[88:91]
    s_waitcnt vmcnt(6)
    s_barrier
    v_mfma_f32_16x16x32_bf16 v[92:95], a[164:167], v[228:231], v[92:95]
    buffer_load_dwordx4 v3, s[12:15], s35 offen offset:2048  lds
    v_mfma_f32_16x16x32_bf16 v[92:95], a[172:175], v[236:239], v[92:95]
    ds_read_b64_tr_b16 a[112:113], v19 offset:0
    ds_read_b64_tr_b16 a[114:115], v19 offset:256
    v_mfma_f32_16x16x32_bf16 v[96:99], a[160:163], a[224:227], v[96:99]
    ds_read_b64_tr_b16 a[116:117], v20 offset:0
    ds_read_b64_tr_b16 a[118:119], v20 offset:256
    v_mfma_f32_16x16x32_bf16 v[96:99], a[168:171], a[232:235], v[96:99]
    ds_read_b64_tr_b16 a[120:121], v19 offset:8192
    ds_read_b64_tr_b16 a[122:123], v19 offset:8448
    v_mfma_f32_16x16x32_bf16 v[100:103], a[160:163], a[228:231], v[100:103]
    buffer_load_dwordx4 v4, s[12:15], s35 offen offset:3072  lds
    v_mfma_f32_16x16x32_bf16 v[100:103], a[168:171], a[236:239], v[100:103]
    buffer_load_dword v0, v34, s[12:15], 0 offen
    ds_read_b64_tr_b16 a[124:125], v20 offset:8192
    v_mfma_f32_16x16x32_bf16 v[104:107], a[164:167], a[224:227], v[104:107]
    s_add_u32 m0, s38, 32768
    ds_read_b64_tr_b16 a[126:127], v20 offset:8448
    v_mfma_f32_16x16x32_bf16 v[104:107], a[172:175], a[232:235], v[104:107]
    s_mov_b32 s35, 4096
    s_waitcnt vmcnt(5)
    s_barrier
    v_mfma_f32_16x16x32_bf16 v[108:111], a[164:167], a[228:231], v[108:111]
    buffer_load_dwordx4 v1, s[12:15], s35 offen offset:0  lds
    v_mfma_f32_16x16x32_bf16 v[108:111], a[172:175], a[236:239], v[108:111]
    ds_read_b64_tr_b16 a[176:177], v19 offset:16384
    ds_read_b64_tr_b16 a[178:179], v19 offset:16640
    s_waitcnt lgkmcnt(8)
    v_mfma_f32_16x16x32_bf16 v[80:83], a[112:115], v[176:179], v[80:83]
    ds_read_b64_tr_b16 a[180:181], v20 offset:16384
    ds_read_b64_tr_b16 a[182:183], v20 offset:16640
    s_waitcnt lgkmcnt(6)
    v_mfma_f32_16x16x32_bf16 v[80:83], a[120:123], v[184:187], v[80:83]
    ds_read_b64_tr_b16 a[184:185], v19 offset:24576
    ds_read_b64_tr_b16 a[186:187], v19 offset:24832
    v_mfma_f32_16x16x32_bf16 v[84:87], a[112:115], v[180:183], v[84:87]
    buffer_load_dwordx4 v2, s[12:15], s35 offen offset:1024  lds
    v_mfma_f32_16x16x32_bf16 v[84:87], a[120:123], v[188:191], v[84:87]
    ds_read_b64_tr_b16 a[188:189], v20 offset:24576
    ds_read_b64_tr_b16 a[190:191], v20 offset:24832
    v_mfma_f32_16x16x32_bf16 v[88:91], a[116:119], v[176:179], v[88:91]
    s_waitcnt lgkmcnt(8)
    v_mfma_f32_16x16x32_bf16 v[88:91], a[124:127], v[184:187], v[88:91]
    v_mfma_f32_16x16x32_bf16 v[92:95], a[116:119], v[180:183], v[92:95]
    buffer_load_dwordx4 v3, s[12:15], s35 offen offset:2048  lds
    v_mfma_f32_16x16x32_bf16 v[92:95], a[124:127], v[188:191], v[92:95]
    s_waitcnt lgkmcnt(6)
    v_mfma_f32_16x16x32_bf16 v[80:83], a[176:179], v[240:243], v[80:83]
    s_waitcnt lgkmcnt(2)
    v_mfma_f32_16x16x32_bf16 v[80:83], a[184:187], v[248:251], v[80:83]
    ds_read_b128 v[176:179], v15 offset:256
    ds_read_b128 v[180:183], v15 offset:8448
    v_mfma_f32_16x16x32_bf16 v[84:87], a[176:179], v[244:247], v[84:87]
    buffer_load_dwordx4 v4, s[12:15], s35 offen offset:3072  lds
    v_mfma_f32_16x16x32_bf16 v[84:87], a[184:187], v[252:255], v[84:87]
    buffer_load_dword v0, v34, s[12:15], 0 offen
    ds_read_b128 v[184:187], v16 offset:256
    v_mfma_f32_16x16x32_bf16 v[88:91], a[180:183], v[240:243], v[88:91]
    ds_read_b128 v[188:191], v16 offset:8448
    s_waitcnt lgkmcnt(4)
    v_mfma_f32_16x16x32_bf16 v[88:91], a[188:191], v[248:251], v[88:91]
    v_mfma_f32_16x16x32_bf16 v[92:95], a[180:183], v[244:247], v[92:95]
    v_mfma_f32_16x16x32_bf16 v[92:95], a[188:191], v[252:255], v[92:95]
    v_mfma_f32_16x16x32_bf16 v[96:99], a[176:179], a[240:243], v[96:99]
    v_mfma_f32_16x16x32_bf16 v[96:99], a[184:187], a[248:251], v[96:99]
    v_mfma_f32_16x16x32_bf16 v[100:103], a[176:179], a[244:247], v[100:103]
    v_mul_f32 v112, s32, v80
    v_mul_f32 v113, s32, v81
    v_mfma_f32_16x16x32_bf16 v[100:103], a[184:187], a[252:255], v[100:103]
    v_mul_f32 v114, s33, v88
    v_mul_f32 v115, s33, v89
    v_mfma_f32_16x16x32_bf16 v[104:107], a[180:183], a[240:243], v[104:107]
    v_min_f32 v112, s34, v112
    v_min_f32 v113, s34, v113
    v_mfma_f32_16x16x32_bf16 v[104:107], a[188:191], a[248:251], v[104:107]
    v_exp_f32 v114, v114
    v_mfma_f32_16x16x32_bf16 v[108:111], a[180:183], a[244:247], v[108:111]
    v_exp_f32 v115, v115
    v_mfma_f32_16x16x32_bf16 v[108:111], a[188:191], a[252:255], v[108:111]
    v_exp_f32 v112, v112
    v_mfma_f32_16x16x32_bf16 v[96:99], a[112:115], v[240:243], v[96:99]
    v_exp_f32 v113, v113
    v_mfma_f32_16x16x32_bf16 v[96:99], a[120:123], v[248:251], v[96:99]
    v_add_f32 v116, 1.0, v112
    v_add_f32 v117, 1.0, v113
    v_mfma_f32_16x16x32_bf16 v[100:103], a[112:115], v[244:247], v[100:103]
    v_fmac_f32 v116, v116, v114
    v_fmac_f32 v117, v117, v115
    v_mfma_f32_16x16x32_bf16 v[100:103], a[120:123], v[252:255], v[100:103]
    v_rcp_f32 v116, v116
    v_mfma_f32_16x16x32_bf16 v[104:107], a[116:119], v[240:243], v[104:107]
    v_rcp_f32 v117, v117
    v_mfma_f32_16x16x32_bf16 v[104:107], a[124:127], v[248:251], v[104:107]
    v_fma_f32 v112, -v112, v116, v116
    v_fma_f32 v113, -v113, v117, v117
    v_mfma_f32_16x16x32_bf16 v[108:111], a[116:119], v[244:247], v[108:111]
    v_cvt_pk_bf16_f32 v124, v112, v113
    v_mul_f32 v118, s32, v82
    v_mfma_f32_16x16x32_bf16 v[108:111], a[124:127], v[252:255], v[108:111]
    v_mul_f32 v119, s32, v83
    v_mul_f32 v120, s33, v90
    v_mfma_f32_16x16x32_bf16 v[48:51], a[112:115], a[240:243], v[48:51]
    v_mul_f32 v121, s33, v91
    v_min_f32 v118, s34, v118
    v_mfma_f32_16x16x32_bf16 v[48:51], a[120:123], a[248:251], v[48:51]
    v_min_f32 v119, s34, v119
    v_mfma_f32_16x16x32_bf16 v[52:55], a[112:115], a[244:247], v[52:55]
    v_exp_f32 v120, v120
    v_mfma_f32_16x16x32_bf16 v[52:55], a[120:123], a[252:255], v[52:55]
    v_exp_f32 v121, v121
    v_mfma_f32_16x16x32_bf16 v[56:59], a[116:119], a[240:243], v[56:59]
    v_exp_f32 v118, v118
    v_mfma_f32_16x16x32_bf16 v[56:59], a[124:127], a[248:251], v[56:59]
    v_exp_f32 v119, v119
    v_mfma_f32_16x16x32_bf16 v[60:63], a[116:119], a[244:247], v[60:63]
    v_add_f32 v122, 1.0, v118
    v_add_f32 v123, 1.0, v119
    v_mfma_f32_16x16x32_bf16 v[60:63], a[124:127], a[252:255], v[60:63]
    v_fmac_f32 v122, v122, v120
    v_fmac_f32 v123, v123, v121
    s_waitcnt lgkmcnt(0)
    s_add_u32 s39, s38, 32768
    v_mfma_f32_16x16x32_bf16 v[80:83], a[128:131], v[128:131], v[48:51]
    s_add_u32 m0, s39, 16384
    s_add_u32 s35, s35, 1024
    v_mfma_f32_16x16x32_bf16 v[80:83], a[136:139], v[136:139], v[80:83]
    v_rcp_f32 v122, v122
    v_mfma_f32_16x16x32_bf16 v[80:83], a[144:147], v[144:147], v[80:83]
    buffer_load_dwordx4 v1, s[12:15], s35 offen offset:0  lds
    v_mfma_f32_16x16x32_bf16 v[80:83], a[152:155], v[152:155], v[80:83]
    v_rcp_f32 v123, v123
    v_mfma_f32_16x16x32_bf16 v[80:83], a[160:163], v[160:163], v[80:83]
    v_fma_f32 v118, -v118, v122, v122
    v_fma_f32 v119, -v119, v123, v123
    v_mfma_f32_16x16x32_bf16 v[80:83], a[168:171], v[168:171], v[80:83]
    v_cvt_pk_bf16_f32 v125, v118, v119
    v_mul_f32 v112, s32, v84
    v_mfma_f32_16x16x32_bf16 v[80:83], a[176:179], v[176:179], v[80:83]
    buffer_load_dwordx4 v2, s[12:15], s35 offen offset:1024  lds
    v_mfma_f32_16x16x32_bf16 v[80:83], a[184:187], v[184:187], v[80:83]
    v_mul_f32 v113, s32, v85
    v_mul_f32 v114, s33, v92
    v_mfma_f32_16x16x32_bf16 v[88:91], a[132:135], v[128:131], v[56:59]
    v_mul_f32 v115, s33, v93
    v_min_f32 v112, s34, v112
    v_mfma_f32_16x16x32_bf16 v[88:91], a[140:143], v[136:139], v[88:91]
    v_min_f32 v113, s34, v113
    v_mul_f32 v118, s32, v86
    v_mfma_f32_16x16x32_bf16 v[88:91], a[148:151], v[144:147], v[88:91]
    buffer_load_dwordx4 v3, s[12:15], s35 offen offset:2048  lds
    v_mfma_f32_16x16x32_bf16 v[88:91], a[156:159], v[152:155], v[88:91]
    v_mul_f32 v119, s32, v87
    v_mul_f32 v120, s33, v94
    v_mfma_f32_16x16x32_bf16 v[88:91], a[164:167], v[160:163], v[88:91]
    v_mul_f32 v121, s33, v95
    v_min_f32 v118, s34, v118
    v_mfma_f32_16x16x32_bf16 v[88:91], a[172:175], v[168:171], v[88:91]
    v_min_f32 v119, s34, v119
    v_mfma_f32_16x16x32_bf16 v[88:91], a[180:183], v[176:179], v[88:91]
    buffer_load_dwordx4 v4, s[12:15], s35 offen offset:3072  lds
    v_mfma_f32_16x16x32_bf16 v[88:91], a[188:191], v[184:187], v[88:91]
    v_exp_f32 v114, v114
    v_mfma_f32_16x16x32_bf16 v[84:87], a[128:131], v[132:135], v[52:55]
    v_exp_f32 v115, v115
    v_mfma_f32_16x16x32_bf16 v[84:87], a[136:139], v[140:143], v[84:87]
    s_xor_b32 s39, s39, 32768
    v_mfma_f32_16x16x32_bf16 v[84:87], a[144:147], v[148:151], v[84:87]
    v_exp_f32 v112, v112
    v_mfma_f32_16x16x32_bf16 v[84:87], a[152:155], v[156:159], v[84:87]
    v_exp_f32 v113, v113
    v_mfma_f32_16x16x32_bf16 v[84:87], a[160:163], v[164:167], v[84:87]
    v_exp_f32 v120, v120
    v_mfma_f32_16x16x32_bf16 v[84:87], a[168:171], v[172:175], v[84:87]
    v_exp_f32 v121, v121
    v_mfma_f32_16x16x32_bf16 v[84:87], a[176:179], v[180:183], v[84:87]
    v_exp_f32 v118, v118
    v_mfma_f32_16x16x32_bf16 v[84:87], a[184:187], v[188:191], v[84:87]
    v_exp_f32 v119, v119
    v_mfma_f32_16x16x32_bf16 v[92:95], a[132:135], v[132:135], v[60:63]
    v_add_f32 v116, 1.0, v112
    v_add_f32 v117, 1.0, v113
    v_mfma_f32_16x16x32_bf16 v[92:95], a[140:143], v[140:143], v[92:95]
    v_fmac_f32 v116, v116, v114
    v_fmac_f32 v117, v117, v115
    v_mfma_f32_16x16x32_bf16 v[92:95], a[148:151], v[148:151], v[92:95]
    v_add_f32 v122, 1.0, v118
    v_add_f32 v123, 1.0, v119
    v_mfma_f32_16x16x32_bf16 v[92:95], a[156:159], v[156:159], v[92:95]
    v_fmac_f32 v122, v122, v120
    v_fmac_f32 v123, v123, v121
    v_mfma_f32_16x16x32_bf16 v[92:95], a[164:167], v[164:167], v[92:95]
    v_rcp_f32 v116, v116
    v_mfma_f32_16x16x32_bf16 v[92:95], a[172:175], v[172:175], v[92:95]
    v_rcp_f32 v117, v117
    v_mfma_f32_16x16x32_bf16 v[92:95], a[180:183], v[180:183], v[92:95]
    v_rcp_f32 v122, v122
    v_mfma_f32_16x16x32_bf16 v[92:95], a[188:191], v[188:191], v[92:95]
    v_rcp_f32 v123, v123
    v_mfma_f32_16x16x32_bf16 v[48:51], a[64:67], v[128:131], v[64:67]
    v_fma_f32 v112, -v112, v116, v116
    v_fma_f32 v113, -v113, v117, v117
    v_mfma_f32_16x16x32_bf16 v[48:51], a[72:75], v[136:139], v[48:51]
    v_cvt_pk_bf16_f32 v126, v112, v113
    v_fma_f32 v118, -v118, v122, v122
    v_mfma_f32_16x16x32_bf16 v[48:51], a[80:83], v[144:147], v[48:51]
    v_fma_f32 v119, -v119, v123, v123
    v_cvt_pk_bf16_f32 v127, v118, v119
    v_mfma_f32_16x16x32_bf16 v[48:51], a[88:91], v[152:155], v[48:51]
    s_mov_b32 s40, 0
    v_permlane32_swap_b32 v124, v126
    v_mfma_f32_16x16x32_bf16 v[48:51], a[96:99], v[160:163], v[48:51]
    v_permlane32_swap_b32 v125, v127
    s_nop 0
    v_mfma_f32_16x16x32_bf16 v[48:51], a[104:107], v[168:171], v[48:51]
    buffer_store_dwordx4 v[124:127], v21, s[20:23], s40 offen
    v_mfma_f32_16x16x32_bf16 v[48:51], a[112:115], v[176:179], v[48:51]
    v_mul_f32 v112, s32, v96
    v_mul_f32 v113, s32, v97
    v_mfma_f32_16x16x32_bf16 v[48:51], a[120:123], v[184:187], v[48:51]
    v_mul_f32 v114, s33, v104
    v_mul_f32 v115, s33, v105
    v_mfma_f32_16x16x32_bf16 v[56:59], a[68:71], v[128:131], v[72:75]
    s_waitcnt vmcnt(11)
    ds_add_u32 v36, v37
    v_mfma_f32_16x16x32_bf16 v[56:59], a[76:79], v[136:139], v[56:59]
    v_min_f32 v112, s34, v112
    v_min_f32 v113, s34, v113
    v_mfma_f32_16x16x32_bf16 v[56:59], a[84:87], v[144:147], v[56:59]
    v_exp_f32 v114, v114
    v_mfma_f32_16x16x32_bf16 v[56:59], a[92:95], v[152:155], v[56:59]
    v_exp_f32 v115, v115
    v_mfma_f32_16x16x32_bf16 v[56:59], a[100:103], v[160:163], v[56:59]
    v_exp_f32 v112, v112
    v_mfma_f32_16x16x32_bf16 v[56:59], a[108:111], v[168:171], v[56:59]
    v_exp_f32 v113, v113
    v_mfma_f32_16x16x32_bf16 v[56:59], a[116:119], v[176:179], v[56:59]
    v_add_f32 v116, 1.0, v112
    v_add_f32 v117, 1.0, v113
    v_mfma_f32_16x16x32_bf16 v[56:59], a[124:127], v[184:187], v[56:59]
    v_fmac_f32 v116, v116, v114
    v_fmac_f32 v117, v117, v115
    v_mfma_f32_16x16x32_bf16 v[52:55], a[64:67], v[132:135], v[68:71]
    v_rcp_f32 v116, v116
    v_mfma_f32_16x16x32_bf16 v[52:55], a[72:75], v[140:143], v[52:55]
    v_rcp_f32 v117, v117
    v_mfma_f32_16x16x32_bf16 v[52:55], a[80:83], v[148:151], v[52:55]
    v_fma_f32 v112, -v112, v116, v116
    v_fma_f32 v113, -v113, v117, v117
    v_mfma_f32_16x16x32_bf16 v[52:55], a[88:91], v[156:159], v[52:55]
    v_cvt_pk_bf16_f32 v124, v112, v113
    v_mul_f32 v118, s32, v98
    v_mfma_f32_16x16x32_bf16 v[52:55], a[96:99], v[164:167], v[52:55]
    ds_read_b32 v38, v36
    v_mul_f32 v119, s32, v99
    v_mfma_f32_16x16x32_bf16 v[52:55], a[104:107], v[172:175], v[52:55]
    v_mul_f32 v120, s33, v106
    v_mul_f32 v121, s33, v107
    v_mfma_f32_16x16x32_bf16 v[52:55], a[112:115], v[180:183], v[52:55]
    v_min_f32 v118, s34, v118
    v_min_f32 v119, s34, v119
    v_mfma_f32_16x16x32_bf16 v[52:55], a[120:123], v[188:191], v[52:55]
    v_exp_f32 v120, v120
    v_mfma_f32_16x16x32_bf16 v[60:63], a[68:71], v[132:135], v[76:79]
    v_exp_f32 v121, v121
    v_mfma_f32_16x16x32_bf16 v[60:63], a[76:79], v[140:143], v[60:63]
    s_waitcnt lgkmcnt(0)
    v_cmp_gt_u32 vcc, s35, v38
    v_mfma_f32_16x16x32_bf16 v[60:63], a[84:87], v[148:151], v[60:63]
    s_cbranch_vccnz L_spin_s2
L_back_s2:
    v_mul_f32 v112, s32, v100
    v_mfma_f32_16x16x32_bf16 v[60:63], a[92:95], v[156:159], v[60:63]
    v_exp_f32 v118, v118
    v_mfma_f32_16x16x32_bf16 v[60:63], a[100:103], v[164:167], v[60:63]
    ds_read_b128 v[192:195], v13 offset:16384
    v_add_f32 v122, 1.0, v118
    v_mfma_f32_16x16x32_bf16 v[60:63], a[108:111], v[172:175], v[60:63]
    ds_read_b128 v[200:203], v14 offset:16384
    v_fmac_f32 v122, v122, v120
    v_mfma_f32_16x16x32_bf16 v[60:63], a[116:119], v[180:183], v[60:63]
    v_exp_f32 v119, v119
    v_mfma_f32_16x16x32_bf16 v[60:63], a[124:127], v[188:191], v[60:63]
    ds_read_b128 v[208:211], v15 offset:16384
    v_add_f32 v123, 1.0, v119
    v_mfma_f32_16x16x32_bf16 v[64:67], a[0:3], v[128:131], 0
    ds_read_b128 v[216:219], v16 offset:16384
    v_fmac_f32 v123, v123, v121
    v_mfma_f32_16x16x32_bf16 v[64:67], a[8:11], v[136:139], v[64:67]
    v_rcp_f32 v122, v122
    v_mfma_f32_16x16x32_bf16 v[64:67], a[16:19], v[144:147], v[64:67]
    ds_read_b128 v[224:227], v13 offset:16640
    v_fma_f32 v118, -v118, v122, v122
    v_mfma_f32_16x16x32_bf16 v[64:67], a[24:27], v[152:155], v[64:67]
    v_rcp_f32 v123, v123
    v_mfma_f32_16x16x32_bf16 v[64:67], a[32:35], v[160:163], v[64:67]
L_stub1:
    s_cbranch_vccnz L_tour_ret
    ds_read_b128 v[232:235], v14 offset:16640
    v_fma_f32 v119, -v119, v123, v123
    v_mfma_f32_16x16x32_bf16 v[64:67], a[40:43], v[168:171], v[64:67]
    ds_read_b128 v[240:243], v15 offset:16640
    v_cvt_pk_bf16_f32 v125, v118, v119
    v_mfma_f32_16x16x32_bf16 v[64:67], a[48:51], v[176:179], v[64:67]
    s_add_u32 s36, s36, 1024
    v_mul_f32 v113, s32, v101
    v_mfma_f32_16x16x32_bf16 v[64:67], a[56:59], v[184:187], v[64:67]
    ds_read_b128 v[248:251], v16 offset:16640
    v_mul_f32 v114, s33, v108
    v_mfma_f32_16x16x32_bf16 v[72:75], a[4:7], v[128:131], 0
    ds_read_b128 v[196:199], v13 offset:24576
    v_mul_f32 v115, s33, v109
    v_mfma_f32_16x16x32_bf16 v[72:75], a[12:15], v[136:139], v[72:75]
    v_min_f32 v112, s34, v112
    v_min_f32 v113, s34, v113
    v_mfma_f32_16x16x32_bf16 v[72:75], a[20:23], v[144:147], v[72:75]
    ds_read_b128 v[204:207], v14 offset:24576
    v_mul_f32 v118, s32, v102
    v_mfma_f32_16x16x32_bf16 v[72:75], a[28:31], v[152:155], v[72:75]
    v_exp_f32 v114, v114
    v_mfma_f32_16x16x32_bf16 v[72:75], a[36:39], v[160:163], v[72:75]
    ds_read_b128 v[212:215], v15 offset:24576
    v_mul_f32 v119, s32, v103
    v_mfma_f32_16x16x32_bf16 v[72:75], a[44:47], v[168:171], v[72:75]
    ds_read_b128 v[220:223], v16 offset:24576
    v_mul_f32 v120, s33, v110
    v_mfma_f32_16x16x32_bf16 v[72:75], a[52:55], v[176:179], v[72:75]
    v_exp_f32 v115, v115
    v_mfma_f32_16x16x32_bf16 v[72:75], a[60:63], v[184:187], v[72:75]
    ds_read_b128 v[228:231], v13 offset:24832
    v_mul_f32 v121, s33, v111
    v_mfma_f32_16x16x32_bf16 v[68:71], a[0:3], v[132:135], 0
    ds_read_b128 v[236:239], v14 offset:24832
    v_min_f32 v118, s34, v118
    v_mfma_f32_16x16x32_bf16 v[68:71], a[8:11], v[140:143], v[68:71]
    v_exp_f32 v112, v112
    v_mfma_f32_16x16x32_bf16 v[68:71], a[16:19], v[148:151], v[68:71]
    ds_read_b128 v[244:247], v15 offset:24832
    v_add_f32 v116, 1.0, v112
    v_mfma_f32_16x16x32_bf16 v[68:71], a[24:27], v[156:159], v[68:71]
    v_exp_f32 v113, v113
    v_mfma_f32_16x16x32_bf16 v[68:71], a[32:35], v[164:167], v[68:71]
    s_waitcnt lgkmcnt(14)
    ds_read_b128 v[252:255], v16 offset:24832
    v_add_f32 v117, 1.0, v113
    v_mfma_f32_16x16x32_bf16 v[68:71], a[40:43], v[172:175], v[68:71]
    v_fmac_f32 v116, v116, v114
    v_fmac_f32 v117, v117, v115
    v_mfma_f32_16x16x32_bf16 v[68:71], a[48:51], v[180:183], v[68:71]
    v_rcp_f32 v116, v116
    v_mfma_f32_16x16x32_bf16 v[68:71], a[56:59], v[188:191], v[68:71]
    v_rcp_f32 v117, v117
    v_mfma_f32_16x16x32_bf16 v[76:79], a[4:7], v[132:135], 0
    v_fma_f32 v112, -v112, v116, v116
    v_fma_f32 v113, -v113, v117, v117
    v_mfma_f32_16x16x32_bf16 v[76:79], a[12:15], v[140:143], v[76:79]
    v_cvt_pk_bf16_f32 v126, v112, v113
    v_min_f32 v119, s34, v119
    v_mfma_f32_16x16x32_bf16 v[76:79], a[20:23], v[148:151], v[76:79]
    v_exp_f32 v120, v120
    v_mfma_f32_16x16x32_bf16 v[76:79], a[28:31], v[156:159], v[76:79]
    v_exp_f32 v121, v121
    v_mfma_f32_16x16x32_bf16 v[76:79], a[36:39], v[164:167], v[76:79]
    v_exp_f32 v118, v118
    v_mfma_f32_16x16x32_bf16 v[76:79], a[44:47], v[172:175], v[76:79]
    v_exp_f32 v119, v119
    v_mfma_f32_16x16x32_bf16 v[76:79], a[52:55], v[180:183], v[76:79]
    v_add_f32 v122, 1.0, v118
    v_add_f32 v123, 1.0, v119
    v_mfma_f32_16x16x32_bf16 v[76:79], a[60:63], v[188:191], v[76:79]
    v_fmac_f32 v122, v122, v120
    v_fmac_f32 v123, v123, v121
    s_waitcnt lgkmcnt(0)
    v_mfma_f32_16x16x32_bf16 v[96:99], a[128:131], v[192:195], v[48:51]
    s_mov_b32 m0, s39
    s_add_u32 s35, s35, 1024
    v_mfma_f32_16x16x32_bf16 v[96:99], a[136:139], v[200:203], v[96:99]
    s_min_u32 s41, s35, 15360
    v_mfma_f32_16x16x32_bf16 v[96:99], a[144:147], v[208:211], v[96:99]
    buffer_load_dwordx4 v1, s[12:15], s41 offen offset:0  lds
    v_mfma_f32_16x16x32_bf16 v[96:99], a[152:155], v[216:219], v[96:99]
    v_rcp_f32 v122, v122
    v_mfma_f32_16x16x32_bf16 v[96:99], a[160:163], v[224:227], v[96:99]
    v_rcp_f32 v123, v123
    v_mfma_f32_16x16x32_bf16 v[96:99], a[168:171], v[232:235], v[96:99]
    v_fma_f32 v118, -v118, v122, v122
    v_fma_f32 v119, -v119, v123, v123
    v_mfma_f32_16x16x32_bf16 v[96:99], a[176:179], v[240:243], v[96:99]
    buffer_load_dwordx4 v2, s[12:15], s41 offen offset:1024  lds
    v_mfma_f32_16x16x32_bf16 v[96:99], a[184:187], v[248:251], v[96:99]
    v_cvt_pk_bf16_f32 v127, v118, v119
    s_nop 0
    v_mfma_f32_16x16x32_bf16 v[104:107], a[132:135], v[192:195], v[56:59]
    v_permlane32_swap_b32 v124, v126
    v_permlane32_swap_b32 v125, v127
    v_mfma_f32_16x16x32_bf16 v[104:107], a[140:143], v[200:203], v[104:107]
    ds_write_b128 v22, v[124:127] offset:4096
    v_mfma_f32_16x16x32_bf16 v[104:107], a[148:151], v[208:211], v[104:107]
    buffer_load_dwordx4 v3, s[12:15], s41 offen offset:2048  lds
    v_mfma_f32_16x16x32_bf16 v[104:107], a[156:159], v[216:219], v[104:107]
    v_mul_f32 v112, s32, v80
    v_mul_f32 v113, s32, v81
    v_mfma_f32_16x16x32_bf16 v[104:107], a[164:167], v[224:227], v[104:107]
    v_mul_f32 v114, s33, v88
    v_mul_f32 v115, s33, v89
    v_mfma_f32_16x16x32_bf16 v[104:107], a[172:175], v[232:235], v[104:107]
    v_min_f32 v112, s34, v112
    v_mfma_f32_16x16x32_bf16 v[104:107], a[180:183], v[240:243], v[104:107]
    buffer_load_dwordx4 v4, s[12:15], s41 offen offset:3072  lds
    v_mfma_f32_16x16x32_bf16 v[104:107], a[188:191], v[248:251], v[104:107]
    v_min_f32 v113, s34, v113
    v_mfma_f32_16x16x32_bf16 v[100:103], a[128:131], v[196:199], v[52:55]
    v_exp_f32 v114, v114
    v_mfma_f32_16x16x32_bf16 v[100:103], a[136:139], v[204:207], v[100:103]
    v_exp_f32 v115, v115
    v_mfma_f32_16x16x32_bf16 v[100:103], a[144:147], v[212:215], v[100:103]
    v_xor_b32 v13, 0x8000, v13
    v_mfma_f32_16x16x32_bf16 v[100:103], a[152:155], v[220:223], v[100:103]
    v_xor_b32 v14, 0x8000, v14
    v_mfma_f32_16x16x32_bf16 v[100:103], a[160:163], v[228:231], v[100:103]
    v_xor_b32 v15, 0x8000, v15
    v_mfma_f32_16x16x32_bf16 v[100:103], a[168:171], v[236:239], v[100:103]
    v_xor_b32 v16, 0x8000, v16
    v_mfma_f32_16x16x32_bf16 v[100:103], a[176:179], v[244:247], v[100:103]
    v_exp_f32 v112, v112
    v_mfma_f32_16x16x32_bf16 v[100:103], a[184:187], v[252:255], v[100:103]
    v_exp_f32 v113, v113
    v_mfma_f32_16x16x32_bf16 v[108:111], a[132:135], v[196:199], v[60:63]
    v_add_f32 v116, 1.0, v112
    v_add_f32 v117, 1.0, v113
    v_mfma_f32_16x16x32_bf16 v[108:111], a[140:143], v[204:207], v[108:111]
    v_fmac_f32 v116, v116, v114
    v_fmac_f32 v117, v117, v115
    v_mfma_f32_16x16x32_bf16 v[108:111], a[148:151], v[212:215], v[108:111]
    v_rcp_f32 v116, v116
    v_mfma_f32_16x16x32_bf16 v[108:111], a[156:159], v[220:223], v[108:111]
    v_rcp_f32 v117, v117
    v_mfma_f32_16x16x32_bf16 v[108:111], a[164:167], v[228:231], v[108:111]
    v_fma_f32 v112, -v112, v116, v116
    v_fma_f32 v113, -v113, v117, v117
    v_mfma_f32_16x16x32_bf16 v[108:111], a[172:175], v[236:239], v[108:111]
    v_cvt_pk_bf16_f32 v124, v112, v113
    v_mul_f32 v118, s32, v82
    v_mfma_f32_16x16x32_bf16 v[108:111], a[180:183], v[244:247], v[108:111]
    v_mul_f32 v119, s32, v83
    v_mul_f32 v120, s33, v90
    v_mfma_f32_16x16x32_bf16 v[108:111], a[188:191], v[252:255], v[108:111]
    v_mul_f32 v121, s33, v91
    v_mfma_f32_16x16x32_bf16 v[48:51], a[64:67], v[192:195], v[64:67]
    v_min_f32 v118, s34, v118
    v_min_f32 v119, s34, v119
    v_mfma_f32_16x16x32_bf16 v[48:51], a[72:75], v[200:203], v[48:51]
    v_mfma_f32_16x16x32_bf16 v[48:51], a[80:83], v[208:211], v[48:51]
    v_exp_f32 v120, v120
    v_mfma_f32_16x16x32_bf16 v[48:51], a[88:91], v[216:219], v[48:51]
    v_exp_f32 v121, v121
    v_mfma_f32_16x16x32_bf16 v[48:51], a[96:99], v[224:227], v[48:51]
    v_exp_f32 v118, v118
    v_mfma_f32_16x16x32_bf16 v[48:51], a[104:107], v[232:235], v[48:51]
    v_exp_f32 v119, v119
    v_mfma_f32_16x16x32_bf16 v[48:51], a[112:115], v[240:243], v[48:51]
    v_add_f32 v122, 1.0, v118
    v_mfma_f32_16x16x32_bf16 v[48:51], a[120:123], v[248:251], v[48:51]
    v_add_f32 v123, 1.0, v119
    v_fmac_f32 v122, v122, v120
    v_mfma_f32_16x16x32_bf16 v[56:59], a[68:71], v[192:195], v[72:75]
    s_waitcnt vmcnt(10)
    ds_add_u32 v36, v37
    v_mfma_f32_16x16x32_bf16 v[56:59], a[76:79], v[200:203], v[56:59]
    v_fmac_f32 v123, v123, v121
    v_mfma_f32_16x16x32_bf16 v[56:59], a[84:87], v[208:211], v[56:59]
    v_rcp_f32 v122, v122
    v_mfma_f32_16x16x32_bf16 v[56:59], a[92:95], v[216:219], v[56:59]
    v_rcp_f32 v123, v123
    v_mfma_f32_16x16x32_bf16 v[56:59], a[100:103], v[224:227], v[56:59]
    v_fma_f32 v118, -v118, v122, v122
    v_mfma_f32_16x16x32_bf16 v[56:59], a[108:111], v[232:235], v[56:59]
    v_fma_f32 v119, -v119, v123, v123
    v_cvt_pk_bf16_f32 v125, v118, v119
    v_mfma_f32_16x16x32_bf16 v[56:59], a[116:119], v[240:243], v[56:59]
    v_mul_f32 v112, s32, v84
    v_mul_f32 v113, s32, v85
    v_mfma_f32_16x16x32_bf16 v[56:59], a[124:127], v[248:251], v[56:59]
    v_mul_f32 v114, s33, v92
    v_mfma_f32_16x16x32_bf16 v[52:55], a[64:67], v[196:199], v[68:71]
    v_mul_f32 v115, s33, v93
    v_min_f32 v112, s34, v112
    v_mfma_f32_16x16x32_bf16 v[52:55], a[72:75], v[204:207], v[52:55]
    v_min_f32 v113, s34, v113
    v_mfma_f32_16x16x32_bf16 v[52:55], a[80:83], v[212:215], v[52:55]
    v_exp_f32 v114, v114
    v_mfma_f32_16x16x32_bf16 v[52:55], a[88:91], v[220:223], v[52:55]
    v_mfma_f32_16x16x32_bf16 v[52:55], a[96:99], v[228:231], v[52:55]
    ds_read_b32 v38, v36
    v_mfma_f32_16x16x32_bf16 v[52:55], a[104:107], v[236:239], v[52:55]
    v_exp_f32 v115, v115
    v_mfma_f32_16x16x32_bf16 v[52:55], a[112:115], v[244:247], v[52:55]
    v_exp_f32 v112, v112
    v_mfma_f32_16x16x32_bf16 v[52:55], a[120:123], v[252:255], v[52:55]
    v_exp_f32 v113, v113
    v_mfma_f32_16x16x32_bf16 v[60:63], a[68:71], v[196:199], v[76:79]
    v_add_f32 v116, 1.0, v112
    v_add_f32 v117, 1.0, v113
    v_mfma_f32_16x16x32_bf16 v[60:63], a[76:79], v[204:207], v[60:63]
    s_waitcnt lgkmcnt(0)
    v_cmp_gt_u32 vcc, s35, v38
    v_mfma_f32_16x16x32_bf16 v[60:63], a[84:87], v[212:215], v[60:63]
    s_cbranch_vccnz L_spin_s3
L_back_s3:
    v_fmac_f32 v116, v116, v114
    v_mfma_f32_16x16x32_bf16 v[60:63], a[92:95], v[220:223], v[60:63]
    ds_read_b128 v[28:31], v23 offset:4096
    v_fmac_f32 v117, v117, v115
    v_mfma_f32_16x16x32_bf16 v[60:63], a[100:103], v[228:231], v[60:63]
    ds_read_b128 v[128:131], v13 offset:0
    v_mfma_f32_16x16x32_bf16 v[60:63], a[108:111], v[236:239], v[60:63]
    ds_read_b128 v[136:139], v14 offset:0
    v_mfma_f32_16x16x32_bf16 v[60:63], a[116:119], v[244:247], v[60:63]
    v_rcp_f32 v116, v116
    v_mfma_f32_16x16x32_bf16 v[60:63], a[124:127], v[252:255], v[60:63]
    ds_read_b128 v[144:147], v15 offset:0
    v_mfma_f32_16x16x32_bf16 v[64:67], a[0:3], v[192:195], 0
    ds_read_b128 v[152:155], v16 offset:0
    v_mfma_f32_16x16x32_bf16 v[64:67], a[8:11], v[200:203], v[64:67]
    v_rcp_f32 v117, v117
    v_mfma_f32_16x16x32_bf16 v[64:67], a[16:19], v[208:211], v[64:67]
    ds_read_b128 v[160:163], v13 offset:256
    v_fma_f32 v112, -v112, v116, v116
    v_mfma_f32_16x16x32_bf16 v[64:67], a[24:27], v[216:219], v[64:67]
    v_fma_f32 v113, -v113, v117, v117
    v_cvt_pk_bf16_f32 v126, v112, v113
    v_mfma_f32_16x16x32_bf16 v[64:67], a[32:35], v[224:227], v[64:67]
    ds_read_b128 v[168:171], v14 offset:256
    v_mul_f32 v118, s32, v86
    v_mfma_f32_16x16x32_bf16 v[64:67], a[40:43], v[232:235], v[64:67]
    ds_read_b128 v[176:179], v15 offset:256
    v_mul_f32 v119, s32, v87
    v_mfma_f32_16x16x32_bf16 v[64:67], a[48:51], v[240:243], v[64:67]
    s_add_u32 s36, s36, 1024
    s_waitcnt lgkmcnt(7)
    v_mfma_f32_16x16x32_bf16 v[64:67], a[56:59], v[248:251], v[64:67]
    ds_read_b128 v[184:187], v16 offset:256
    buffer_store_dwordx4 v[28:31], v24, s[20:23], s36 offen sc1
    v_mfma_f32_16x16x32_bf16 v[72:75], a[4:7], v[192:195], 0
    ds_read_b128 v[132:135], v13 offset:8192
    v_mul_f32 v120, s33, v94
    v_mfma_f32_16x16x32_bf16 v[72:75], a[12:15], v[200:203], v[72:75]
    v_mul_f32 v121, s33, v95
    v_min_f32 v118, s34, v118
    v_mfma_f32_16x16x32_bf16 v[72:75], a[20:23], v[208:211], v[72:75]
    ds_read_b128 v[140:143], v14 offset:8192
    v_min_f32 v119, s34, v119
    v_mfma_f32_16x16x32_bf16 v[72:75], a[28:31], v[216:219], v[72:75]
    v_exp_f32 v120, v120
    v_mfma_f32_16x16x32_bf16 v[72:75], a[36:39], v[224:227], v[72:75]
    ds_read_b128 v[148:151], v15 offset:8192
    v_mfma_f32_16x16x32_bf16 v[72:75], a[44:47], v[232:235], v[72:75]
    ds_read_b128 v[156:159], v16 offset:8192
    v_mfma_f32_16x16x32_bf16 v[72:75], a[52:55], v[240:243], v[72:75]
    v_exp_f32 v121, v121
    v_mfma_f32_16x16x32_bf16 v[72:75], a[60:63], v[248:251], v[72:75]
    ds_read_b128 v[164:167], v13 offset:8448
    v_mfma_f32_16x16x32_bf16 v[68:71], a[0:3], v[196:199], 0
    ds_read_b128 v[172:175], v14 offset:8448
    v_mfma_f32_16x16x32_bf16 v[68:71], a[8:11], v[204:207], v[68:71]
    v_exp_f32 v118, v118
    v_mfma_f32_16x16x32_bf16 v[68:71], a[16:19], v[212:215], v[68:71]
    ds_read_b128 v[180:183], v15 offset:8448
    v_mfma_f32_16x16x32_bf16 v[68:71], a[24:27], v[220:223], v[68:71]
    v_exp_f32 v119, v119
    v_mfma_f32_16x16x32_bf16 v[68:71], a[32:35], v[228:231], v[68:71]
    s_waitcnt lgkmcnt(14)
    ds_read_b128 v[188:191], v16 offset:8448
    v_add_f32 v122, 1.0, v118
    v_mfma_f32_16x16x32_bf16 v[68:71], a[40:43], v[236:239], v[68:71]
    v_add_f32 v123, 1.0, v119
    v_fmac_f32 v122, v122, v120
    v_mfma_f32_16x16x32_bf16 v[68:71], a[48:51], v[244:247], v[68:71]
    v_fmac_f32 v123, v123, v121
    v_mfma_f32_16x16x32_bf16 v[68:71], a[56:59], v[252:255], v[68:71]
    v_rcp_f32 v122, v122
    v_mfma_f32_16x16x32_bf16 v[76:79], a[4:7], v[196:199], 0
    v_rcp_f32 v123, v123
    v_mfma_f32_16x16x32_bf16 v[76:79], a[12:15], v[204:207], v[76:79]
    v_fma_f32 v118, -v118, v122, v122
    v_fma_f32 v119, -v119, v123, v123
    v_mfma_f32_16x16x32_bf16 v[76:79], a[20:23], v[212:215], v[76:79]
    v_cvt_pk_bf16_f32 v127, v118, v119
    s_nop 0
    v_mfma_f32_16x16x32_bf16 v[76:79], a[28:31], v[220:223], v[76:79]
    v_permlane32_swap_b32 v124, v126
    v_permlane32_swap_b32 v125, v127
    v_mfma_f32_16x16x32_bf16 v[76:79], a[36:39], v[228:231], v[76:79]
    s_waitcnt lgkmcnt(14)
    ds_write_b128 v22, v[124:127] offset:0
    v_mfma_f32_16x16x32_bf16 v[76:79], a[44:47], v[236:239], v[76:79]
    v_mfma_f32_16x16x32_bf16 v[76:79], a[52:55], v[244:247], v[76:79]
    v_mfma_f32_16x16x32_bf16 v[76:79], a[60:63], v[252:255], v[76:79]
    s_branch L_loop
L_spin_s2:
    ds_read_b32 v38, v36
    s_waitcnt lgkmcnt(0)
    v_cmp_gt_u32 vcc, s35, v38
    s_cbranch_vccnz L_spin_s2
    s_branch L_back_s2
L_spin_s3:
    ds_read_b32 v38, v36
    s_waitcnt lgkmcnt(0)
    v_cmp_gt_u32 vcc, s35, v38
    s_cbranch_vccnz L_spin_s3
    s_branch L_back_s3
L_spin_e:
    ds_read_b32 v38, v36
    s_waitcnt lgkmcnt(0)
    v_cmp_gt_u32 vcc, s35, v38
    s_cbranch_vccnz L_spin_e
    s_branch L_back_e
L_spin_o:
    ds_read_b32 v38, v36
    s_waitcnt lgkmcnt(0)
    v_cmp_gt_u32 vcc, s35, v38
    s_cbranch_vccnz L_spin_o
    s_branch L_back_o
L_spin_s12:
    ds_read_b32 v38, v36
    s_waitcnt lgkmcnt(0)
    v_cmp_gt_u32 vcc, s35, v38
    s_cbranch_vccnz L_spin_s12
    s_branch L_back_s12
L_spin_s13:
    ds_read_b32 v38, v36
    s_waitcnt lgkmcnt(0)
    v_cmp_gt_u32 vcc, s35, v38
    s_cbranch_vccnz L_spin_s13
    s_branch L_back_s13
L_spin_t0:
    ds_read_b32 v38, v36
    s_waitcnt lgkmcnt(0)
    v_cmp_gt_u32 vcc, 0x4400, v38
    s_cbranch_vccnz L_spin_t0
    s_branch L_back_t0
.p2align 6
L_loop:
    s_waitcnt lgkmcnt(1)
    v_mfma_f32_16x16x32_bf16 v[80:83], a[128:131], v[128:131], v[48:51]
    s_add_u32 m0, s39, 16384
    s_add_u32 s35, s35, 1024
    v_mfma_f32_16x16x32_bf16 v[80:83], a[136:139], v[136:139], v[80:83]
    v_mfma_f32_16x16x32_bf16 v[80:83], a[144:147], v[144:147], v[80:83]
    buffer_load_dwordx4 v1, s[12:15], s35 offen offset:0  lds
    v_mfma_f32_16x16x32_bf16 v[80:83], a[152:155], v[152:155], v[80:83]
    v_mul_f32 v112, s32, v96
    v_mul_f32 v113, s32, v97
    v_mfma_f32_16x16x32_bf16 v[80:83], a[160:163], v[160:163], v[80:83]
    v_mul_f32 v114, s33, v104
    v_mfma_f32_16x16x32_bf16 v[80:83], a[168:171], v[168:171], v[80:83]
    v_mul_f32 v115, s33, v105
    v_min_f32 v112, s34, v112
    v_mfma_f32_16x16x32_bf16 v[80:83], a[176:179], v[176:179], v[80:83]
    buffer_load_dwordx4 v2, s[12:15], s35 offen offset:1024  lds
    v_mfma_f32_16x16x32_bf16 v[80:83], a[184:187], v[184:187], v[80:83]
    v_min_f32 v113, s34, v113
    v_mfma_f32_16x16x32_bf16 v[88:91], a[132:135], v[128:131], v[56:59]
    v_exp_f32 v114, v114
    v_mfma_f32_16x16x32_bf16 v[88:91], a[140:143], v[136:139], v[88:91]
    v_mfma_f32_16x16x32_bf16 v[88:91], a[148:151], v[144:147], v[88:91]
    buffer_load_dwordx4 v3, s[12:15], s35 offen offset:2048  lds
    v_mfma_f32_16x16x32_bf16 v[88:91], a[156:159], v[152:155], v[88:91]
    v_exp_f32 v115, v115
    v_mfma_f32_16x16x32_bf16 v[88:91], a[164:167], v[160:163], v[88:91]
    v_exp_f32 v112, v112
    v_mfma_f32_16x16x32_bf16 v[88:91], a[172:175], v[168:171], v[88:91]
    v_mfma_f32_16x16x32_bf16 v[88:91], a[180:183], v[176:179], v[88:91]
    buffer_load_dwordx4 v4, s[12:15], s35 offen offset:3072  lds
    v_mfma_f32_16x16x32_bf16 v[88:91], a[188:191], v[184:187], v[88:91]
    v_exp_f32 v113, v113
    v_mfma_f32_16x16x32_bf16 v[84:87], a[128:131], v[132:135], v[52:55]
    v_add_f32 v116, 1.0, v112
    v_add_f32 v117, 1.0, v113
    v_mfma_f32_16x16x32_bf16 v[84:87], a[136:139], v[140:143], v[84:87]
    s_xor_b32 s39, s39, 32768
    v_fmac_f32 v116, v116, v114
    v_mfma_f32_16x16x32_bf16 v[84:87], a[144:147], v[148:151], v[84:87]
    v_fmac_f32 v117, v117, v115
    v_mfma_f32_16x16x32_bf16 v[84:87], a[152:155], v[156:159], v[84:87]
    v_rcp_f32 v116, v116
    v_mfma_f32_16x16x32_bf16 v[84:87], a[160:163], v[164:167], v[84:87]
    s_waitcnt vmcnt(10)
    ds_add_u32 v36, v37
    v_mfma_f32_16x16x32_bf16 v[84:87], a[168:171], v[172:175], v[84:87]
    v_mfma_f32_16x16x32_bf16 v[84:87], a[176:179], v[180:183], v[84:87]
    v_rcp_f32 v117, v117
    v_mfma_f32_16x16x32_bf16 v[84:87], a[184:187], v[188:191], v[84:87]
    v_fma_f32 v112, -v112, v116, v116
    v_fma_f32 v113, -v113, v117, v117
    v_mfma_f32_16x16x32_bf16 v[92:95], a[132:135], v[132:135], v[60:63]
    v_cvt_pk_bf16_f32 v124, v112, v113
    v_mul_f32 v118, s32, v98
    v_mfma_f32_16x16x32_bf16 v[92:95], a[140:143], v[140:143], v[92:95]
    v_mul_f32 v119, s32, v99
    v_mfma_f32_16x16x32_bf16 v[92:95], a[148:151], v[148:151], v[92:95]
    v_mul_f32 v120, s33, v106
    v_mul_f32 v121, s33, v107
    v_mfma_f32_16x16x32_bf16 v[92:95], a[156:159], v[156:159], v[92:95]
    v_min_f32 v118, s34, v118
    v_mfma_f32_16x16x32_bf16 v[92:95], a[164:167], v[164:167], v[92:95]
    v_min_f32 v119, s34, v119
    v_mfma_f32_16x16x32_bf16 v[92:95], a[172:175], v[172:175], v[92:95]
    v_exp_f32 v120, v120
    v_mfma_f32_16x16x32_bf16 v[92:95], a[180:183], v[180:183], v[92:95]
    v_mfma_f32_16x16x32_bf16 v[92:95], a[188:191], v[188:191], v[92:95]
    v_exp_f32 v121, v121
    v_mfma_f32_16x16x32_bf16 v[48:51], a[64:67], v[128:131], v[64:67]
    v_exp_f32 v118, v118
    v_mfma_f32_16x16x32_bf16 v[48:51], a[72:75], v[136:139], v[48:51]
    v_exp_f32 v119, v119
    v_mfma_f32_16x16x32_bf16 v[48:51], a[80:83], v[144:147], v[48:51]
    ds_read_b32 v38, v36
    v_mfma_f32_16x16x32_bf16 v[48:51], a[88:91], v[152:155], v[48:51]
    v_add_f32 v122, 1.0, v118
    v_add_f32 v123, 1.0, v119
    v_mfma_f32_16x16x32_bf16 v[48:51], a[96:99], v[160:163], v[48:51]
    v_fmac_f32 v122, v122, v120
    v_mfma_f32_16x16x32_bf16 v[48:51], a[104:107], v[168:171], v[48:51]
    v_fmac_f32 v123, v123, v121
    v_mfma_f32_16x16x32_bf16 v[48:51], a[112:115], v[176:179], v[48:51]
    v_rcp_f32 v122, v122
    v_mfma_f32_16x16x32_bf16 v[48:51], a[120:123], v[184:187], v[48:51]
    s_waitcnt lgkmcnt(0)
    v_cmp_gt_u32 vcc, s35, v38
    v_mfma_f32_16x16x32_bf16 v[56:59], a[68:71], v[128:131], v[72:75]
    s_cbranch_vccnz L_spin_e
L_back_e:
    v_mfma_f32_16x16x32_bf16 v[56:59], a[76:79], v[136:139], v[56:59]
    ds_read_b128 v[28:31], v23 offset:0
    v_mfma_f32_16x16x32_bf16 v[56:59], a[84:87], v[144:147], v[56:59]
    ds_read_b128 v[192:195], v13 offset:16384
    v_mfma_f32_16x16x32_bf16 v[56:59], a[92:95], v[152:155], v[56:59]
    v_rcp_f32 v123, v123
    v_mfma_f32_16x16x32_bf16 v[56:59], a[100:103], v[160:163], v[56:59]
    ds_read_b128 v[200:203], v14 offset:16384
    v_fma_f32 v118, -v118, v122, v122
    v_mfma_f32_16x16x32_bf16 v[56:59], a[108:111], v[168:171], v[56:59]
    v_fma_f32 v119, -v119, v123, v123
    v_cvt_pk_bf16_f32 v125, v118, v119
    v_mfma_f32_16x16x32_bf16 v[56:59], a[116:119], v[176:179], v[56:59]
    v_mul_f32 v112, s32, v100
    v_mul_f32 v113, s32, v101
    v_mfma_f32_16x16x32_bf16 v[56:59], a[124:127], v[184:187], v[56:59]
    ds_read_b128 v[208:211], v15 offset:16384
    v_mul_f32 v114, s33, v108
    v_mfma_f32_16x16x32_bf16 v[52:55], a[64:67], v[132:135], v[68:71]
    v_mul_f32 v115, s33, v109
    v_mfma_f32_16x16x32_bf16 v[52:55], a[72:75], v[140:143], v[52:55]
    v_min_f32 v112, s34, v112
    v_min_f32 v113, s34, v113
    v_mfma_f32_16x16x32_bf16 v[52:55], a[80:83], v[148:151], v[52:55]
    ds_read_b128 v[216:219], v16 offset:16384
    v_mfma_f32_16x16x32_bf16 v[52:55], a[88:91], v[156:159], v[52:55]
    v_exp_f32 v114, v114
    v_mfma_f32_16x16x32_bf16 v[52:55], a[96:99], v[164:167], v[52:55]
    s_add_u32 s36, s36, 1024
    s_waitcnt lgkmcnt(4)
    v_mfma_f32_16x16x32_bf16 v[52:55], a[104:107], v[172:175], v[52:55]
    ds_read_b128 v[224:227], v13 offset:16640
    buffer_store_dwordx4 v[28:31], v24, s[20:23], s36 offen sc1
    v_mfma_f32_16x16x32_bf16 v[52:55], a[112:115], v[180:183], v[52:55]
    v_mfma_f32_16x16x32_bf16 v[52:55], a[120:123], v[188:191], v[52:55]
    v_exp_f32 v115, v115
    v_mfma_f32_16x16x32_bf16 v[60:63], a[68:71], v[132:135], v[76:79]
    ds_read_b128 v[232:235], v14 offset:16640
    v_mfma_f32_16x16x32_bf16 v[60:63], a[76:79], v[140:143], v[60:63]
    v_exp_f32 v112, v112
    v_mfma_f32_16x16x32_bf16 v[60:63], a[84:87], v[148:151], v[60:63]
    ds_read_b128 v[240:243], v15 offset:16640
    v_mfma_f32_16x16x32_bf16 v[60:63], a[92:95], v[156:159], v[60:63]
    v_exp_f32 v113, v113
    v_mfma_f32_16x16x32_bf16 v[60:63], a[100:103], v[164:167], v[60:63]
    v_add_f32 v116, 1.0, v112
    v_add_f32 v117, 1.0, v113
    v_mfma_f32_16x16x32_bf16 v[60:63], a[108:111], v[172:175], v[60:63]
    ds_read_b128 v[248:251], v16 offset:16640
    v_fmac_f32 v116, v116, v114
    v_mfma_f32_16x16x32_bf16 v[60:63], a[116:119], v[180:183], v[60:63]
    v_fmac_f32 v117, v117, v115
    v_mfma_f32_16x16x32_bf16 v[60:63], a[124:127], v[188:191], v[60:63]
    v_rcp_f32 v116, v116
    v_mfma_f32_16x16x32_bf16 v[64:67], a[0:3], v[128:131], 0
    ds_read_b128 v[196:199], v13 offset:24576
    v_mfma_f32_16x16x32_bf16 v[64:67], a[8:11], v[136:139], v[64:67]
    v_rcp_f32 v117, v117
    v_mfma_f32_16x16x32_bf16 v[64:67], a[16:19], v[144:147], v[64:67]
    v_fma_f32 v112, -v112, v116, v116
    v_fma_f32 v113, -v113, v117, v117
    v_mfma_f32_16x16x32_bf16 v[64:67], a[24:27], v[152:155], v[64:67]
    ds_read_b128 v[204:207], v14 offset:24576
    v_cvt_pk_bf16_f32 v126, v112, v113
    v_mfma_f32_16x16x32_bf16 v[64:67], a[32:35], v[160:163], v[64:67]
    v_mul_f32 v118, s32, v102
    v_mfma_f32_16x16x32_bf16 v[64:67], a[40:43], v[168:171], v[64:67]
    v_mul_f32 v119, s32, v103
    v_mfma_f32_16x16x32_bf16 v[64:67], a[48:51], v[176:179], v[64:67]
    ds_read_b128 v[212:215], v15 offset:24576
    v_mul_f32 v120, s33, v110
    v_mfma_f32_16x16x32_bf16 v[64:67], a[56:59], v[184:187], v[64:67]
    v_mul_f32 v121, s33, v111
    v_min_f32 v118, s34, v118
    v_mfma_f32_16x16x32_bf16 v[72:75], a[4:7], v[128:131], 0
    ds_read_b128 v[220:223], v16 offset:24576
    v_mfma_f32_16x16x32_bf16 v[72:75], a[12:15], v[136:139], v[72:75]
    v_min_f32 v119, s34, v119
    v_mfma_f32_16x16x32_bf16 v[72:75], a[20:23], v[144:147], v[72:75]
    v_exp_f32 v120, v120
    v_mfma_f32_16x16x32_bf16 v[72:75], a[28:31], v[152:155], v[72:75]
    ds_read_b128 v[228:231], v13 offset:24832
    v_mfma_f32_16x16x32_bf16 v[72:75], a[36:39], v[160:163], v[72:75]
    v_exp_f32 v121, v121
    v_mfma_f32_16x16x32_bf16 v[72:75], a[44:47], v[168:171], v[72:75]
    v_exp_f32 v118, v118
    v_mfma_f32_16x16x32_bf16 v[72:75], a[52:55], v[176:179], v[72:75]
    ds_read_b128 v[236:239], v14 offset:24832
    v_mfma_f32_16x16x32_bf16 v[72:75], a[60:63], v[184:187], v[72:75]
    v_exp_f32 v119, v119
    v_mfma_f32_16x16x32_bf16 v[68:71], a[0:3], v[132:135], 0
    v_add_f32 v122, 1.0, v118
    v_mfma_f32_16x16x32_bf16 v[68:71], a[8:11], v[140:143], v[68:71]
    ds_read_b128 v[244:247], v15 offset:24832
    v_add_f32 v123, 1.0, v119
    v_mfma_f32_16x16x32_bf16 v[68:71], a[16:19], v[148:151], v[68:71]
    v_fmac_f32 v122, v122, v120
    v_fmac_f32 v123, v123, v121
    v_mfma_f32_16x16x32_bf16 v[68:71], a[24:27], v[156:159], v[68:71]
    v_mfma_f32_16x16x32_bf16 v[68:71], a[32:35], v[164:167], v[68:71]
    s_waitcnt lgkmcnt(14)
    ds_read_b128 v[252:255], v16 offset:24832
    v_mfma_f32_16x16x32_bf16 v[68:71], a[40:43], v[172:175], v[68:71]
    v_rcp_f32 v122, v122
    v_mfma_f32_16x16x32_bf16 v[68:71], a[48:51], v[180:183], v[68:71]
    v_rcp_f32 v123, v123
    v_mfma_f32_16x16x32_bf16 v[68:71], a[56:59], v[188:191], v[68:71]
    v_fma_f32 v118, -v118, v122, v122
    v_fma_f32 v119, -v119, v123, v123
    v_mfma_f32_16x16x32_bf16 v[76:79], a[4:7], v[132:135], 0
    v_cvt_pk_bf16_f32 v127, v118, v119
    v_mfma_f32_16x16x32_bf16 v[76:79], a[12:15], v[140:143], v[76:79]
    s_nop 0
    v_permlane32_swap_b32 v124, v126
    v_mfma_f32_16x16x32_bf16 v[76:79], a[20:23], v[148:151], v[76:79]
    v_permlane32_swap_b32 v125, v127
    v_mfma_f32_16x16x32_bf16 v[76:79], a[28:31], v[156:159], v[76:79]
    s_waitcnt lgkmcnt(14)
    ds_write_b128 v22, v[124:127] offset:4096
    v_mfma_f32_16x16x32_bf16 v[76:79], a[36:39], v[164:167], v[76:79]
    v_mfma_f32_16x16x32_bf16 v[76:79], a[44:47], v[172:175], v[76:79]
    v_mfma_f32_16x16x32_bf16 v[76:79], a[52:55], v[180:183], v[76:79]
    v_mfma_f32_16x16x32_bf16 v[76:79], a[60:63], v[188:191], v[76:79]
    s_waitcnt lgkmcnt(1)
    v_mfma_f32_16x16x32_bf16 v[96:99], a[128:131], v[192:195], v[48:51]
    s_mov_b32 m0, s39
    s_add_u32 s35, s35, 1024
    v_mfma_f32_16x16x32_bf16 v[96:99], a[136:139], v[200:203], v[96:99]
    s_min_u32 s41, s35, 15360
    v_mfma_f32_16x16x32_bf16 v[96:99], a[144:147], v[208:211], v[96:99]
    buffer_load_dwordx4 v1, s[12:15], s41 offen offset:0  lds
    v_mfma_f32_16x16x32_bf16 v[96:99], a[152:155], v[216:219], v[96:99]
    v_mul_f32 v112, s32, v80
    v_mul_f32 v113, s32, v81
    v_mfma_f32_16x16x32_bf16 v[96:99], a[160:163], v[224:227], v[96:99]
    v_mul_f32 v114, s33, v88
    v_mfma_f32_16x16x32_bf16 v[96:99], a[168:171], v[232:235], v[96:99]
    v_mul_f32 v115, s33, v89
    v_min_f32 v112, s34, v112
    v_mfma_f32_16x16x32_bf16 v[96:99], a[176:179], v[240:243], v[96:99]
    buffer_load_dwordx4 v2, s[12:15], s41 offen offset:1024  lds
    v_mfma_f32_16x16x32_bf16 v[96:99], a[184:187], v[248:251], v[96:99]
    v_min_f32 v113, s34, v113
    v_mfma_f32_16x16x32_bf16 v[104:107], a[132:135], v[192:195], v[56:59]
    v_exp_f32 v114, v114
    v_mfma_f32_16x16x32_bf16 v[104:107], a[140:143], v[200:203], v[104:107]
    v_mfma_f32_16x16x32_bf16 v[104:107], a[148:151], v[208:211], v[104:107]
    buffer_load_dwordx4 v3, s[12:15], s41 offen offset:2048  lds
    v_mfma_f32_16x16x32_bf16 v[104:107], a[156:159], v[216:219], v[104:107]
    v_exp_f32 v115, v115
    v_mfma_f32_16x16x32_bf16 v[104:107], a[164:167], v[224:227], v[104:107]
    v_exp_f32 v112, v112
    v_mfma_f32_16x16x32_bf16 v[104:107], a[172:175], v[232:235], v[104:107]
    v_exp_f32 v113, v113
    v_mfma_f32_16x16x32_bf16 v[104:107], a[180:183], v[240:243], v[104:107]
    buffer_load_dwordx4 v4, s[12:15], s41 offen offset:3072  lds
    v_mfma_f32_16x16x32_bf16 v[104:107], a[188:191], v[248:251], v[104:107]
    v_add_f32 v116, 1.0, v112
    v_mfma_f32_16x16x32_bf16 v[100:103], a[128:131], v[196:199], v[52:55]
    v_add_f32 v117, 1.0, v113
    v_fmac_f32 v116, v116, v114
    v_mfma_f32_16x16x32_bf16 v[100:103], a[136:139], v[204:207], v[100:103]
    v_fmac_f32 v117, v117, v115
    v_mfma_f32_16x16x32_bf16 v[100:103], a[144:147], v[212:215], v[100:103]
    v_xor_b32 v13, 0x8000, v13
    v_mfma_f32_16x16x32_bf16 v[100:103], a[152:155], v[220:223], v[100:103]
    v_xor_b32 v14, 0x8000, v14
    v_mfma_f32_16x16x32_bf16 v[100:103], a[160:163], v[228:231], v[100:103]
    v_xor_b32 v15, 0x8000, v15
    s_waitcnt vmcnt(10)
    ds_add_u32 v36, v37
    v_mfma_f32_16x16x32_bf16 v[100:103], a[168:171], v[236:239], v[100:103]
    v_xor_b32 v16, 0x8000, v16
    v_mfma_f32_16x16x32_bf16 v[100:103], a[176:179], v[244:247], v[100:103]
    v_rcp_f32 v116, v116
    v_mfma_f32_16x16x32_bf16 v[100:103], a[184:187], v[252:255], v[100:103]
    v_rcp_f32 v117, v117
    v_mfma_f32_16x16x32_bf16 v[108:111], a[132:135], v[196:199], v[60:63]
    v_fma_f32 v112, -v112, v116, v116
    v_fma_f32 v113, -v113, v117, v117
    v_mfma_f32_16x16x32_bf16 v[108:111], a[140:143], v[204:207], v[108:111]
    v_cvt_pk_bf16_f32 v124, v112, v113
    v_mul_f32 v118, s32, v82
    v_mfma_f32_16x16x32_bf16 v[108:111], a[148:151], v[212:215], v[108:111]
    v_mul_f32 v119, s32, v83
    v_mfma_f32_16x16x32_bf16 v[108:111], a[156:159], v[220:223], v[108:111]
    v_mul_f32 v120, s33, v90
    v_mul_f32 v121, s33, v91
    v_mfma_f32_16x16x32_bf16 v[108:111], a[164:167], v[228:231], v[108:111]
    v_min_f32 v118, s34, v118
    v_mfma_f32_16x16x32_bf16 v[108:111], a[172:175], v[236:239], v[108:111]
    v_min_f32 v119, s34, v119
    v_mfma_f32_16x16x32_bf16 v[108:111], a[180:183], v[244:247], v[108:111]
    v_exp_f32 v120, v120
    v_mfma_f32_16x16x32_bf16 v[108:111], a[188:191], v[252:255], v[108:111]
    v_exp_f32 v121, v121
    v_mfma_f32_16x16x32_bf16 v[48:51], a[64:67], v[192:195], v[64:67]
    v_mfma_f32_16x16x32_bf16 v[48:51], a[72:75], v[200:203], v[48:51]
    v_exp_f32 v118, v118
    v_mfma_f32_16x16x32_bf16 v[48:51], a[80:83], v[208:211], v[48:51]
    ds_read_b32 v38, v36
    v_mfma_f32_16x16x32_bf16 v[48:51], a[88:91], v[216:219], v[48:51]
    v_exp_f32 v119, v119
L_stub2:
    s_cbranch_vccnz L_tour_ret
    v_mfma_f32_16x16x32_bf16 v[48:51], a[96:99], v[224:227], v[48:51]
    v_add_f32 v122, 1.0, v118
    v_add_f32 v123, 1.0, v119
    v_mfma_f32_16x16x32_bf16 v[48:51], a[104:107], v[232:235], v[48:51]
    v_fmac_f32 v122, v122, v120
    v_fmac_f32 v123, v123, v121
    v_mfma_f32_16x16x32_bf16 v[48:51], a[112:115], v[240:243], v[48:51]
    v_mfma_f32_16x16x32_bf16 v[48:51], a[120:123], v[248:251], v[48:51]
    s_waitcnt lgkmcnt(0)
    v_cmp_gt_u32 vcc, s35, v38
    v_mfma_f32_16x16x32_bf16 v[56:59], a[68:71], v[192:195], v[72:75]
    s_cbranch_vccnz L_spin_o
L_back_o:
    v_mfma_f32_16x16x32_bf16 v[56:59], a[76:79], v[200:203], v[56:59]
    ds_read_b128 v[28:31], v23 offset:4096
    v_mfma_f32_16x16x32_bf16 v[56:59], a[84:87], v[208:211], v[56:59]
    ds_read_b128 v[128:131], v13 offset:0
    v_mfma_f32_16x16x32_bf16 v[56:59], a[92:95], v[216:219], v[56:59]
    v_rcp_f32 v122, v122
    v_mfma_f32_16x16x32_bf16 v[56:59], a[100:103], v[224:227], v[56:59]
    ds_read_b128 v[136:139], v14 offset:0
    v_mfma_f32_16x16x32_bf16 v[56:59], a[108:111], v[232:235], v[56:59]
    v_rcp_f32 v123, v123
    v_mfma_f32_16x16x32_bf16 v[56:59], a[116:119], v[240:243], v[56:59]
    v_fma_f32 v118, -v118, v122, v122
    v_fma_f32 v119, -v119, v123, v123
    v_mfma_f32_16x16x32_bf16 v[56:59], a[124:127], v[248:251], v[56:59]
    ds_read_b128 v[144:147], v15 offset:0
    v_cvt_pk_bf16_f32 v125, v118, v119
    v_mfma_f32_16x16x32_bf16 v[52:55], a[64:67], v[196:199], v[68:71]
    v_mul_f32 v112, s32, v84
    v_mul_f32 v113, s32, v85
    v_mfma_f32_16x16x32_bf16 v[52:55], a[72:75], v[204:207], v[52:55]
    v_mul_f32 v114, s33, v92
    v_mul_f32 v115, s33, v93
    v_mfma_f32_16x16x32_bf16 v[52:55], a[80:83], v[212:215], v[52:55]
    ds_read_b128 v[152:155], v16 offset:0
    v_min_f32 v112, s34, v112
    v_mfma_f32_16x16x32_bf16 v[52:55], a[88:91], v[220:223], v[52:55]
    v_min_f32 v113, s34, v113
    v_mfma_f32_16x16x32_bf16 v[52:55], a[96:99], v[228:231], v[52:55]
    s_add_u32 s36, s36, 1024
    s_waitcnt lgkmcnt(4)
    v_mfma_f32_16x16x32_bf16 v[52:55], a[104:107], v[236:239], v[52:55]
    ds_read_b128 v[160:163], v13 offset:256
    buffer_store_dwordx4 v[28:31], v24, s[20:23], s36 offen sc1
    v_mfma_f32_16x16x32_bf16 v[52:55], a[112:115], v[244:247], v[52:55]
    v_exp_f32 v114, v114
    v_mfma_f32_16x16x32_bf16 v[52:55], a[120:123], v[252:255], v[52:55]
    v_exp_f32 v115, v115
    v_mfma_f32_16x16x32_bf16 v[60:63], a[68:71], v[196:199], v[76:79]
    ds_read_b128 v[168:171], v14 offset:256
    v_mfma_f32_16x16x32_bf16 v[60:63], a[76:79], v[204:207], v[60:63]
    v_exp_f32 v112, v112
    v_mfma_f32_16x16x32_bf16 v[60:63], a[84:87], v[212:215], v[60:63]
    ds_read_b128 v[176:179], v15 offset:256
    v_mfma_f32_16x16x32_bf16 v[60:63], a[92:95], v[220:223], v[60:63]
    v_exp_f32 v113, v113
    v_mfma_f32_16x16x32_bf16 v[60:63], a[100:103], v[228:231], v[60:63]
    v_add_f32 v116, 1.0, v112
    v_add_f32 v117, 1.0, v113
    v_mfma_f32_16x16x32_bf16 v[60:63], a[108:111], v[236:239], v[60:63]
    ds_read_b128 v[184:187], v16 offset:256
    v_fmac_f32 v116, v116, v114
    v_mfma_f32_16x16x32_bf16 v[60:63], a[116:119], v[244:247], v[60:63]
    v_fmac_f32 v117, v117, v115
    v_mfma_f32_16x16x32_bf16 v[60:63], a[124:127], v[252:255], v[60:63]
    v_rcp_f32 v116, v116
    v_mfma_f32_16x16x32_bf16 v[64:67], a[0:3], v[192:195], 0
    ds_read_b128 v[132:135], v13 offset:8192
    v_mfma_f32_16x16x32_bf16 v[64:67], a[8:11], v[200:203], v[64:67]
    v_rcp_f32 v117, v117
    v_mfma_f32_16x16x32_bf16 v[64:67], a[16:19], v[208:211], v[64:67]
    v_fma_f32 v112, -v112, v116, v116
    v_mfma_f32_16x16x32_bf16 v[64:67], a[24:27], v[216:219], v[64:67]
    ds_read_b128 v[140:143], v14 offset:8192
    v_fma_f32 v113, -v113, v117, v117
    v_mfma_f32_16x16x32_bf16 v[64:67], a[32:35], v[224:227], v[64:67]
    v_cvt_pk_bf16_f32 v126, v112, v113
    v_mul_f32 v118, s32, v86
    v_mfma_f32_16x16x32_bf16 v[64:67], a[40:43], v[232:235], v[64:67]
    v_mul_f32 v119, s32, v87
    v_mfma_f32_16x16x32_bf16 v[64:67], a[48:51], v[240:243], v[64:67]
    ds_read_b128 v[148:151], v15 offset:8192
    v_mul_f32 v120, s33, v94
    v_mfma_f32_16x16x32_bf16 v[64:67], a[56:59], v[248:251], v[64:67]
    v_mul_f32 v121, s33, v95
    v_mfma_f32_16x16x32_bf16 v[72:75], a[4:7], v[192:195], 0
    ds_read_b128 v[156:159], v16 offset:8192
    v_min_f32 v118, s34, v118
    v_mfma_f32_16x16x32_bf16 v[72:75], a[12:15], v[200:203], v[72:75]
    v_min_f32 v119, s34, v119
    v_mfma_f32_16x16x32_bf16 v[72:75], a[20:23], v[208:211], v[72:75]
    v_exp_f32 v120, v120
    v_mfma_f32_16x16x32_bf16 v[72:75], a[28:31], v[216:219], v[72:75]
    ds_read_b128 v[164:167], v13 offset:8448
    v_mfma_f32_16x16x32_bf16 v[72:75], a[36:39], v[224:227], v[72:75]
    v_exp_f32 v121, v121
    v_mfma_f32_16x16x32_bf16 v[72:75], a[44:47], v[232:235], v[72:75]
    v_mfma_f32_16x16x32_bf16 v[72:75], a[52:55], v[240:243], v[72:75]
    ds_read_b128 v[172:175], v14 offset:8448
    v_mfma_f32_16x16x32_bf16 v[72:75], a[60:63], v[248:251], v[72:75]
    v_exp_f32 v118, v118
    v_mfma_f32_16x16x32_bf16 v[68:71], a[0:3], v[196:199], 0
    v_exp_f32 v119, v119
    v_mfma_f32_16x16x32_bf16 v[68:71], a[8:11], v[204:207], v[68:71]
    ds_read_b128 v[180:183], v15 offset:8448
    v_add_f32 v122, 1.0, v118
    v_mfma_f32_16x16x32_bf16 v[68:71], a[16:19], v[212:215], v[68:71]
    v_add_f32 v123, 1.0, v119
    v_fmac_f32 v122, v122, v120
    v_mfma_f32_16x16x32_bf16 v[68:71], a[24:27], v[220:223], v[68:71]
    v_fmac_f32 v123, v123, v121
    v_mfma_f32_16x16x32_bf16 v[68:71], a[32:35], v[228:231], v[68:71]
    s_waitcnt lgkmcnt(14)
    ds_read_b128 v[188:191], v16 offset:8448
    v_mfma_f32_16x16x32_bf16 v[68:71], a[40:43], v[236:239], v[68:71]
    v_rcp_f32 v122, v122
    v_mfma_f32_16x16x32_bf16 v[68:71], a[48:51], v[244:247], v[68:71]
    v_rcp_f32 v123, v123
    v_mfma_f32_16x16x32_bf16 v[68:71], a[56:59], v[252:255], v[68:71]
    v_fma_f32 v118, -v118, v122, v122
    v_fma_f32 v119, -v119, v123, v123
    v_mfma_f32_16x16x32_bf16 v[76:79], a[4:7], v[196:199], 0
    v_cvt_pk_bf16_f32 v127, v118, v119
    v_mfma_f32_16x16x32_bf16 v[76:79], a[12:15], v[204:207], v[76:79]
    s_nop 0
    v_permlane32_swap_b32 v124, v126
    v_mfma_f32_16x16x32_bf16 v[76:79], a[20:23], v[212:215], v[76:79]
    v_permlane32_swap_b32 v125, v127
    v_mfma_f32_16x16x32_bf16 v[76:79], a[28:31], v[220:223], v[76:79]
    s_waitcnt lgkmcnt(14)
    ds_write_b128 v22, v[124:127] offset:0
    v_mfma_f32_16x16x32_bf16 v[76:79], a[36:39], v[228:231], v[76:79]
    v_mfma_f32_16x16x32_bf16 v[76:79], a[44:47], v[236:239], v[76:79]
    v_mfma_f32_16x16x32_bf16 v[76:79], a[52:55], v[244:247], v[76:79]
    v_mfma_f32_16x16x32_bf16 v[76:79], a[60:63], v[252:255], v[76:79]
    s_cmp_lt_u32 s35, 14336
    s_cbranch_scc1 L_loop
    s_waitcnt lgkmcnt(1)
    v_mfma_f32_16x16x32_bf16 v[80:83], a[128:131], v[128:131], v[48:51]
    s_add_u32 m0, s39, 16384
    s_add_u32 s35, s35, 1024
    v_mfma_f32_16x16x32_bf16 v[80:83], a[136:139], v[136:139], v[80:83]
    v_mfma_f32_16x16x32_bf16 v[80:83], a[144:147], v[144:147], v[80:83]
    buffer_load_dwordx4 v1, s[12:15], s35 offen offset:0  lds
    v_mfma_f32_16x16x32_bf16 v[80:83], a[152:155], v[152:155], v[80:83]
    v_mul_f32 v112, s32, v96
    v_mul_f32 v113, s32, v97
    v_mfma_f32_16x16x32_bf16 v[80:83], a[160:163], v[160:163], v[80:83]
    v_mul_f32 v114, s33, v104
    v_mul_f32 v115, s33, v105
    v_mfma_f32_16x16x32_bf16 v[80:83], a[168:171], v[168:171], v[80:83]
    v_min_f32 v112, s34, v112
    v_min_f32 v113, s34, v113
    v_mfma_f32_16x16x32_bf16 v[80:83], a[176:179], v[176:179], v[80:83]
    buffer_load_dwordx4 v2, s[12:15], s35 offen offset:1024  lds
    v_mfma_f32_16x16x32_bf16 v[80:83], a[184:187], v[184:187], v[80:83]
    v_exp_f32 v114, v114
    v_mfma_f32_16x16x32_bf16 v[88:91], a[132:135], v[128:131], v[56:59]
    v_exp_f32 v115, v115
    v_mfma_f32_16x16x32_bf16 v[88:91], a[140:143], v[136:139], v[88:91]
    v_exp_f32 v112, v112
    v_mfma_f32_16x16x32_bf16 v[88:91], a[148:151], v[144:147], v[88:91]
    buffer_load_dwordx4 v3, s[12:15], s35 offen offset:2048  lds
    v_mfma_f32_16x16x32_bf16 v[88:91], a[156:159], v[152:155], v[88:91]
    v_exp_f32 v113, v113
    v_mfma_f32_16x16x32_bf16 v[88:91], a[164:167], v[160:163], v[88:91]
    v_add_f32 v116, 1.0, v112
    v_add_f32 v117, 1.0, v113
    v_mfma_f32_16x16x32_bf16 v[88:91], a[172:175], v[168:171], v[88:91]
    v_fmac_f32 v116, v116, v114
    v_fmac_f32 v117, v117, v115
    v_mfma_f32_16x16x32_bf16 v[88:91], a[180:183], v[176:179], v[88:91]
    buffer_load_dwordx4 v4, s[12:15], s35 offen offset:3072  lds
    v_mfma_f32_16x16x32_bf16 v[88:91], a[188:191], v[184:187], v[88:91]
    v_rcp_f32 v116, v116
    v_mfma_f32_16x16x32_bf16 v[84:87], a[128:131], v[132:135], v[52:55]
    s_waitcnt vmcnt(10)
    ds_add_u32 v36, v37
    v_mfma_f32_16x16x32_bf16 v[84:87], a[136:139], v[140:143], v[84:87]
    s_xor_b32 s39, s39, 32768
    v_fma_f32 v112, -v112, v116, v116
    v_mfma_f32_16x16x32_bf16 v[84:87], a[144:147], v[148:151], v[84:87]
    v_rcp_f32 v117, v117
    v_mfma_f32_16x16x32_bf16 v[84:87], a[152:155], v[156:159], v[84:87]
    v_fma_f32 v113, -v113, v117, v117
    v_cvt_pk_bf16_f32 v124, v112, v113
    v_mfma_f32_16x16x32_bf16 v[84:87], a[160:163], v[164:167], v[84:87]
    v_mul_f32 v118, s32, v98
    v_mul_f32 v119, s32, v99
    v_mfma_f32_16x16x32_bf16 v[84:87], a[168:171], v[172:175], v[84:87]
    v_mul_f32 v120, s33, v106
    v_mul_f32 v121, s33, v107
    v_mfma_f32_16x16x32_bf16 v[84:87], a[176:179], v[180:183], v[84:87]
    v_min_f32 v118, s34, v118
    v_min_f32 v119, s34, v119
    v_mfma_f32_16x16x32_bf16 v[84:87], a[184:187], v[188:191], v[84:87]
    v_exp_f32 v120, v120
    v_mfma_f32_16x16x32_bf16 v[92:95], a[132:135], v[132:135], v[60:63]
    v_exp_f32 v121, v121
    v_mfma_f32_16x16x32_bf16 v[92:95], a[140:143], v[140:143], v[92:95]
    v_exp_f32 v118, v118
    v_mfma_f32_16x16x32_bf16 v[92:95], a[148:151], v[148:151], v[92:95]
    v_exp_f32 v119, v119
    v_mfma_f32_16x16x32_bf16 v[92:95], a[156:159], v[156:159], v[92:95]
    v_add_f32 v122, 1.0, v118
    v_add_f32 v123, 1.0, v119
    v_mfma_f32_16x16x32_bf16 v[92:95], a[164:167], v[164:167], v[92:95]
    v_fmac_f32 v122, v122, v120
    v_fmac_f32 v123, v123, v121
    v_mfma_f32_16x16x32_bf16 v[92:95], a[172:175], v[172:175], v[92:95]
    v_rcp_f32 v122, v122
    v_mfma_f32_16x16x32_bf16 v[92:95], a[180:183], v[180:183], v[92:95]
    ds_read_b32 v38, v36
    v_fma_f32 v118, -v118, v122, v122
    v_mfma_f32_16x16x32_bf16 v[92:95], a[188:191], v[188:191], v[92:95]
    v_rcp_f32 v123, v123
    v_mfma_f32_16x16x32_bf16 v[48:51], a[64:67], v[128:131], v[64:67]
    v_fma_f32 v119, -v119, v123, v123
    v_cvt_pk_bf16_f32 v125, v118, v119
    v_mfma_f32_16x16x32_bf16 v[48:51], a[72:75], v[136:139], v[48:51]
    v_mul_f32 v112, s32, v100
    v_mul_f32 v113, s32, v101
    v_mfma_f32_16x16x32_bf16 v[48:51], a[80:83], v[144:147], v[48:51]
    v_mul_f32 v114, s33, v108
    v_mul_f32 v115, s33, v109
    v_mfma_f32_16x16x32_bf16 v[48:51], a[88:91], v[152:155], v[48:51]
    s_waitcnt lgkmcnt(0)
    v_cmp_gt_u32 vcc, s35, v38
    v_mfma_f32_16x16x32_bf16 v[48:51], a[96:99], v[160:163], v[48:51]
    s_cbranch_vccnz L_spin_s12
L_back_s12:
    v_min_f32 v112, s34, v112
    v_mfma_f32_16x16x32_bf16 v[48:51], a[104:107], v[168:171], v[48:51]
    ds_read_b128 v[28:31], v23 offset:0
    v_min_f32 v113, s34, v113
    v_mfma_f32_16x16x32_bf16 v[48:51], a[112:115], v[176:179], v[48:51]
    ds_read_b128 v[192:195], v13 offset:16384
    v_mul_f32 v118, s32, v102
    v_mfma_f32_16x16x32_bf16 v[48:51], a[120:123], v[184:187], v[48:51]
    v_exp_f32 v114, v114
    v_mfma_f32_16x16x32_bf16 v[56:59], a[68:71], v[128:131], v[72:75]
    v_exp_f32 v115, v115
    v_mfma_f32_16x16x32_bf16 v[56:59], a[76:79], v[136:139], v[56:59]
    ds_read_b128 v[200:203], v14 offset:16384
    v_mul_f32 v119, s32, v103
    v_mfma_f32_16x16x32_bf16 v[56:59], a[84:87], v[144:147], v[56:59]
    v_exp_f32 v112, v112
    v_mfma_f32_16x16x32_bf16 v[56:59], a[92:95], v[152:155], v[56:59]
    v_exp_f32 v113, v113
    v_mfma_f32_16x16x32_bf16 v[56:59], a[100:103], v[160:163], v[56:59]
    ds_read_b128 v[208:211], v15 offset:16384
    v_add_f32 v116, 1.0, v112
    v_mfma_f32_16x16x32_bf16 v[56:59], a[108:111], v[168:171], v[56:59]
    v_add_f32 v117, 1.0, v113
    v_fmac_f32 v116, v116, v114
    v_mfma_f32_16x16x32_bf16 v[56:59], a[116:119], v[176:179], v[56:59]
    v_fmac_f32 v117, v117, v115
    v_mul_f32 v120, s33, v110
    v_mfma_f32_16x16x32_bf16 v[56:59], a[124:127], v[184:187], v[56:59]
    ds_read_b128 v[216:219], v16 offset:16384
    v_mul_f32 v121, s33, v111
    v_mfma_f32_16x16x32_bf16 v[52:55], a[64:67], v[132:135], v[68:71]
    s_add_u32 s36, s36, 1024
    s_waitcnt lgkmcnt(4)
    v_mfma_f32_16x16x32_bf16 v[52:55], a[72:75], v[140:143], v[52:55]
    buffer_store_dwordx4 v[28:31], v24, s[20:23], s36 offen sc1
    v_mfma_f32_16x16x32_bf16 v[52:55], a[80:83], v[148:151], v[52:55]
    ds_read_b128 v[224:227], v13 offset:16640
    v_min_f32 v118, s34, v118
    v_mfma_f32_16x16x32_bf16 v[52:55], a[88:91], v[156:159], v[52:55]
    v_rcp_f32 v116, v116
    v_mfma_f32_16x16x32_bf16 v[52:55], a[96:99], v[164:167], v[52:55]
    v_rcp_f32 v117, v117
    v_mfma_f32_16x16x32_bf16 v[52:55], a[104:107], v[172:175], v[52:55]
    ds_read_b128 v[232:235], v14 offset:16640
    v_fma_f32 v112, -v112, v116, v116
    v_mfma_f32_16x16x32_bf16 v[52:55], a[112:115], v[180:183], v[52:55]
    v_fma_f32 v113, -v113, v117, v117
    v_cvt_pk_bf16_f32 v126, v112, v113
    v_mfma_f32_16x16x32_bf16 v[52:55], a[120:123], v[188:191], v[52:55]
    v_min_f32 v119, s34, v119
    v_mfma_f32_16x16x32_bf16 v[60:63], a[68:71], v[132:135], v[76:79]
    ds_read_b128 v[240:243], v15 offset:16640
    v_mfma_f32_16x16x32_bf16 v[60:63], a[76:79], v[140:143], v[60:63]
    v_exp_f32 v120, v120
    v_mfma_f32_16x16x32_bf16 v[60:63], a[84:87], v[148:151], v[60:63]
    v_exp_f32 v121, v121
    v_mfma_f32_16x16x32_bf16 v[60:63], a[92:95], v[156:159], v[60:63]
    ds_read_b128 v[248:251], v16 offset:16640
    v_mfma_f32_16x16x32_bf16 v[60:63], a[100:103], v[164:167], v[60:63]
    v_exp_f32 v118, v118
    v_mfma_f32_16x16x32_bf16 v[60:63], a[108:111], v[172:175], v[60:63]
    v_exp_f32 v119, v119
    v_mfma_f32_16x16x32_bf16 v[60:63], a[116:119], v[180:183], v[60:63]
    ds_read_b128 v[196:199], v13 offset:24576
    v_add_f32 v122, 1.0, v118
    v_mfma_f32_16x16x32_bf16 v[60:63], a[124:127], v[188:191], v[60:63]
    v_add_f32 v123, 1.0, v119
    v_fmac_f32 v122, v122, v120
    v_mfma_f32_16x16x32_bf16 v[64:67], a[0:3], v[128:131], 0
    v_fmac_f32 v123, v123, v121
    v_mfma_f32_16x16x32_bf16 v[64:67], a[8:11], v[136:139], v[64:67]
    ds_read_b128 v[204:207], v14 offset:24576
    v_mfma_f32_16x16x32_bf16 v[64:67], a[16:19], v[144:147], v[64:67]
    v_rcp_f32 v122, v122
    v_mfma_f32_16x16x32_bf16 v[64:67], a[24:27], v[152:155], v[64:67]
    v_rcp_f32 v123, v123
    v_mfma_f32_16x16x32_bf16 v[64:67], a[32:35], v[160:163], v[64:67]
    ds_read_b128 v[212:215], v15 offset:24576
    v_fma_f32 v118, -v118, v122, v122
    v_mfma_f32_16x16x32_bf16 v[64:67], a[40:43], v[168:171], v[64:67]
    v_fma_f32 v119, -v119, v123, v123
    v_cvt_pk_bf16_f32 v127, v118, v119
    v_mfma_f32_16x16x32_bf16 v[64:67], a[48:51], v[176:179], v[64:67]
    s_nop 0
    v_permlane32_swap_b32 v124, v126
    v_mfma_f32_16x16x32_bf16 v[64:67], a[56:59], v[184:187], v[64:67]
    ds_read_b128 v[220:223], v16 offset:24576
    v_permlane32_swap_b32 v125, v127
    v_mfma_f32_16x16x32_bf16 v[72:75], a[4:7], v[128:131], 0
    ds_write_b128 v22, v[124:127] offset:4096
    v_mul_f32 v112, s32, v80
    v_mfma_f32_16x16x32_bf16 v[72:75], a[12:15], v[136:139], v[72:75]
    v_mul_f32 v113, s32, v81
    v_mul_f32 v114, s33, v88
    v_mfma_f32_16x16x32_bf16 v[72:75], a[20:23], v[144:147], v[72:75]
    ds_read_b128 v[228:231], v13 offset:24832
    v_mul_f32 v115, s33, v89
    v_mfma_f32_16x16x32_bf16 v[72:75], a[28:31], v[152:155], v[72:75]
    v_min_f32 v112, s34, v112
    v_min_f32 v113, s34, v113
    v_mfma_f32_16x16x32_bf16 v[72:75], a[36:39], v[160:163], v[72:75]
    v_exp_f32 v114, v114
    v_mfma_f32_16x16x32_bf16 v[72:75], a[44:47], v[168:171], v[72:75]
    ds_read_b128 v[236:239], v14 offset:24832
    v_mul_f32 v118, s32, v82
    v_mfma_f32_16x16x32_bf16 v[72:75], a[52:55], v[176:179], v[72:75]
    v_exp_f32 v115, v115
    v_mfma_f32_16x16x32_bf16 v[72:75], a[60:63], v[184:187], v[72:75]
    v_exp_f32 v112, v112
    v_mfma_f32_16x16x32_bf16 v[68:71], a[0:3], v[132:135], 0
    s_waitcnt lgkmcnt(14)
    ds_read_b128 v[244:247], v15 offset:24832
    v_add_f32 v116, 1.0, v112
    v_mfma_f32_16x16x32_bf16 v[68:71], a[8:11], v[140:143], v[68:71]
    v_exp_f32 v113, v113
    v_mfma_f32_16x16x32_bf16 v[68:71], a[16:19], v[148:151], v[68:71]
    v_add_f32 v117, 1.0, v113
    v_fmac_f32 v116, v116, v114
    v_mfma_f32_16x16x32_bf16 v[68:71], a[24:27], v[156:159], v[68:71]
    v_fmac_f32 v117, v117, v115
    v_mul_f32 v119, s32, v83
    v_mfma_f32_16x16x32_bf16 v[68:71], a[32:35], v[164:167], v[68:71]
    s_waitcnt lgkmcnt(14)
    ds_read_b128 v[252:255], v16 offset:24832
    v_mul_f32 v120, s33, v90
    v_mfma_f32_16x16x32_bf16 v[68:71], a[40:43], v[172:175], v[68:71]
    v_rcp_f32 v116, v116
    v_mfma_f32_16x16x32_bf16 v[68:71], a[48:51], v[180:183], v[68:71]
    v_rcp_f32 v117, v117
    v_mfma_f32_16x16x32_bf16 v[68:71], a[56:59], v[188:191], v[68:71]
    v_fma_f32 v112, -v112, v116, v116
    v_fma_f32 v113, -v113, v117, v117
    v_mfma_f32_16x16x32_bf16 v[76:79], a[4:7], v[132:135], 0
    v_cvt_pk_bf16_f32 v124, v112, v113
    v_mul_f32 v121, s33, v91
    v_mfma_f32_16x16x32_bf16 v[76:79], a[12:15], v[140:143], v[76:79]
    v_min_f32 v118, s34, v118
    v_min_f32 v119, s34, v119
    v_mfma_f32_16x16x32_bf16 v[76:79], a[20:23], v[148:151], v[76:79]
    v_exp_f32 v120, v120
    v_mfma_f32_16x16x32_bf16 v[76:79], a[28:31], v[156:159], v[76:79]
    v_exp_f32 v121, v121
    v_mfma_f32_16x16x32_bf16 v[76:79], a[36:39], v[164:167], v[76:79]
    v_exp_f32 v118, v118
    v_mfma_f32_16x16x32_bf16 v[76:79], a[44:47], v[172:175], v[76:79]
    v_exp_f32 v119, v119
    v_mfma_f32_16x16x32_bf16 v[76:79], a[52:55], v[180:183], v[76:79]
    v_add_f32 v122, 1.0, v118
    v_add_f32 v123, 1.0, v119
    v_mfma_f32_16x16x32_bf16 v[76:79], a[60:63], v[188:191], v[76:79]
    v_fmac_f32 v122, v122, v120
    v_fmac_f32 v123, v123, v121
    s_waitcnt lgkmcnt(0)
    v_mfma_f32_16x16x32_bf16 v[96:99], a[128:131], v[192:195], v[48:51]
    s_add_u32 s35, s35, 1024
    v_mfma_f32_16x16x32_bf16 v[96:99], a[136:139], v[200:203], v[96:99]
    v_mfma_f32_16x16x32_bf16 v[96:99], a[144:147], v[208:211], v[96:99]
    v_rcp_f32 v122, v122
    v_mfma_f32_16x16x32_bf16 v[96:99], a[152:155], v[216:219], v[96:99]
    v_rcp_f32 v123, v123
    v_mfma_f32_16x16x32_bf16 v[96:99], a[160:163], v[224:227], v[96:99]
    v_fma_f32 v118, -v118, v122, v122
    v_fma_f32 v119, -v119, v123, v123
    v_mfma_f32_16x16x32_bf16 v[96:99], a[168:171], v[232:235], v[96:99]
    v_cvt_pk_bf16_f32 v125, v118, v119
    v_mul_f32 v112, s32, v84
    v_mfma_f32_16x16x32_bf16 v[96:99], a[176:179], v[240:243], v[96:99]
    v_mul_f32 v113, s32, v85
    v_mul_f32 v114, s33, v92
    v_mfma_f32_16x16x32_bf16 v[96:99], a[184:187], v[248:251], v[96:99]
    v_mul_f32 v115, s33, v93
    v_min_f32 v112, s34, v112
    v_mfma_f32_16x16x32_bf16 v[104:107], a[132:135], v[192:195], v[56:59]
    v_min_f32 v113, s34, v113
    v_mul_f32 v118, s32, v86
    v_mfma_f32_16x16x32_bf16 v[104:107], a[140:143], v[200:203], v[104:107]
    v_exp_f32 v114, v114
    v_mfma_f32_16x16x32_bf16 v[104:107], a[148:151], v[208:211], v[104:107]
    v_exp_f32 v115, v115
    v_mfma_f32_16x16x32_bf16 v[104:107], a[156:159], v[216:219], v[104:107]
    v_exp_f32 v112, v112
    v_mfma_f32_16x16x32_bf16 v[104:107], a[164:167], v[224:227], v[104:107]
    v_exp_f32 v113, v113
    v_mfma_f32_16x16x32_bf16 v[104:107], a[172:175], v[232:235], v[104:107]
    v_add_f32 v116, 1.0, v112
    v_add_f32 v117, 1.0, v113
    v_mfma_f32_16x16x32_bf16 v[104:107], a[180:183], v[240:243], v[104:107]
    v_fmac_f32 v116, v116, v114
    v_fmac_f32 v117, v117, v115
    v_mfma_f32_16x16x32_bf16 v[104:107], a[188:191], v[248:251], v[104:107]
    v_rcp_f32 v116, v116
    v_mfma_f32_16x16x32_bf16 v[100:103], a[128:131], v[196:199], v[52:55]
    s_waitcnt vmcnt(6)
    ds_add_u32 v36, v37
    v_mfma_f32_16x16x32_bf16 v[100:103], a[136:139], v[204:207], v[100:103]
    v_rcp_f32 v117, v117
    v_mfma_f32_16x16x32_bf16 v[100:103], a[144:147], v[212:215], v[100:103]
    v_xor_b32 v13, 0x8000, v13
    v_fma_f32 v112, -v112, v116, v116
    v_mfma_f32_16x16x32_bf16 v[100:103], a[152:155], v[220:223], v[100:103]
    v_xor_b32 v14, 0x8000, v14
    v_fma_f32 v113, -v113, v117, v117
    v_mfma_f32_16x16x32_bf16 v[100:103], a[160:163], v[228:231], v[100:103]
    v_xor_b32 v15, 0x8000, v15
    v_cvt_pk_bf16_f32 v126, v112, v113
    v_mfma_f32_16x16x32_bf16 v[100:103], a[168:171], v[236:239], v[100:103]
    v_xor_b32 v16, 0x8000, v16
    v_mul_f32 v119, s32, v87
    v_mfma_f32_16x16x32_bf16 v[100:103], a[176:179], v[244:247], v[100:103]
    v_mul_f32 v120, s33, v94
    v_mul_f32 v121, s33, v95
    v_mfma_f32_16x16x32_bf16 v[100:103], a[184:187], v[252:255], v[100:103]
    v_min_f32 v118, s34, v118
    v_min_f32 v119, s34, v119
    v_mfma_f32_16x16x32_bf16 v[108:111], a[132:135], v[196:199], v[60:63]
    v_exp_f32 v120, v120
    v_mfma_f32_16x16x32_bf16 v[108:111], a[140:143], v[204:207], v[108:111]
    v_exp_f32 v121, v121
    v_mfma_f32_16x16x32_bf16 v[108:111], a[148:151], v[212:215], v[108:111]
    v_exp_f32 v118, v118
    v_mfma_f32_16x16x32_bf16 v[108:111], a[156:159], v[220:223], v[108:111]
    v_exp_f32 v119, v119
    v_mfma_f32_16x16x32_bf16 v[108:111], a[164:167], v[228:231], v[108:111]
    v_add_f32 v122, 1.0, v118
    v_add_f32 v123, 1.0, v119
    v_mfma_f32_16x16x32_bf16 v[108:111], a[172:175], v[236:239], v[108:111]
    v_fmac_f32 v122, v122, v120
    v_fmac_f32 v123, v123, v121
    v_mfma_f32_16x16x32_bf16 v[108:111], a[180:183], v[244:247], v[108:111]
    ds_read_b32 v38, v36
    v_mfma_f32_16x16x32_bf16 v[108:111], a[188:191], v[252:255], v[108:111]
    v_rcp_f32 v122, v122
    v_mfma_f32_16x16x32_bf16 v[48:51], a[64:67], v[192:195], v[64:67]
    v_rcp_f32 v123, v123
    v_mfma_f32_16x16x32_bf16 v[48:51], a[72:75], v[200:203], v[48:51]
    v_fma_f32 v118, -v118, v122, v122
    v_fma_f32 v119, -v119, v123, v123
    v_mfma_f32_16x16x32_bf16 v[48:51], a[80:83], v[208:211], v[48:51]
    v_cvt_pk_bf16_f32 v127, v118, v119
    s_nop 0
    v_mfma_f32_16x16x32_bf16 v[48:51], a[88:91], v[216:219], v[48:51]
    s_waitcnt lgkmcnt(0)
    v_cmp_gt_u32 vcc, s35, v38
    v_mfma_f32_16x16x32_bf16 v[48:51], a[96:99], v[224:227], v[48:51]
    s_cbranch_vccnz L_spin_s13
L_back_s13:
    v_permlane32_swap_b32 v124, v126
    v_mfma_f32_16x16x32_bf16 v[48:51], a[104:107], v[232:235], v[48:51]
    ds_read_b128 v[28:31], v23 offset:4096
    v_permlane32_swap_b32 v125, v127
    v_mfma_f32_16x16x32_bf16 v[48:51], a[112:115], v[240:243], v[48:51]
    ds_read_b128 v[128:131], v13 offset:0
    ds_write_b128 v22, v[124:127] offset:0
    v_mfma_f32_16x16x32_bf16 v[48:51], a[120:123], v[248:251], v[48:51]
    v_mul_f32 v112, s32, v96
    v_mul_f32 v113, s32, v97
    v_mfma_f32_16x16x32_bf16 v[56:59], a[68:71], v[192:195], v[72:75]
    v_mul_f32 v114, s33, v104
    v_mul_f32 v115, s33, v105
    v_mfma_f32_16x16x32_bf16 v[56:59], a[76:79], v[200:203], v[56:59]
    ds_read_b128 v[136:139], v14 offset:0
    v_min_f32 v112, s34, v112
    v_mfma_f32_16x16x32_bf16 v[56:59], a[84:87], v[208:211], v[56:59]
    v_min_f32 v113, s34, v113
    v_mul_f32 v118, s32, v98
    v_mfma_f32_16x16x32_bf16 v[56:59], a[92:95], v[216:219], v[56:59]
    v_exp_f32 v114, v114
    v_mfma_f32_16x16x32_bf16 v[56:59], a[100:103], v[224:227], v[56:59]
    ds_read_b128 v[144:147], v15 offset:0
    v_mul_f32 v119, s32, v99
    v_mfma_f32_16x16x32_bf16 v[56:59], a[108:111], v[232:235], v[56:59]
    v_exp_f32 v115, v115
    v_mfma_f32_16x16x32_bf16 v[56:59], a[116:119], v[240:243], v[56:59]
    v_exp_f32 v112, v112
    v_mfma_f32_16x16x32_bf16 v[56:59], a[124:127], v[248:251], v[56:59]
    ds_read_b128 v[152:155], v16 offset:0
    v_add_f32 v116, 1.0, v112
    v_mfma_f32_16x16x32_bf16 v[52:55], a[64:67], v[196:199], v[68:71]
    s_add_u32 s36, s36, 1024
    s_waitcnt lgkmcnt(5)
    v_mfma_f32_16x16x32_bf16 v[52:55], a[72:75], v[204:207], v[52:55]
    buffer_store_dwordx4 v[28:31], v24, s[20:23], s36 offen sc1
    v_mfma_f32_16x16x32_bf16 v[52:55], a[80:83], v[212:215], v[52:55]
    ds_read_b128 v[160:163], v13 offset:256
    v_fmac_f32 v116, v116, v114
    v_mfma_f32_16x16x32_bf16 v[52:55], a[88:91], v[220:223], v[52:55]
    v_exp_f32 v113, v113
    v_mfma_f32_16x16x32_bf16 v[52:55], a[96:99], v[228:231], v[52:55]
    v_add_f32 v117, 1.0, v113
    v_fmac_f32 v117, v117, v115
    v_mfma_f32_16x16x32_bf16 v[52:55], a[104:107], v[236:239], v[52:55]
    ds_read_b128 v[168:171], v14 offset:256
    v_mul_f32 v120, s33, v106
    v_mfma_f32_16x16x32_bf16 v[52:55], a[112:115], v[244:247], v[52:55]
    v_rcp_f32 v116, v116
    v_mfma_f32_16x16x32_bf16 v[52:55], a[120:123], v[252:255], v[52:55]
    v_rcp_f32 v117, v117
    v_mfma_f32_16x16x32_bf16 v[60:63], a[68:71], v[196:199], v[76:79]
    ds_read_b128 v[176:179], v15 offset:256
    v_fma_f32 v112, -v112, v116, v116
    v_mfma_f32_16x16x32_bf16 v[60:63], a[76:79], v[204:207], v[60:63]
    v_fma_f32 v113, -v113, v117, v117
    v_cvt_pk_bf16_f32 v124, v112, v113
    v_mfma_f32_16x16x32_bf16 v[60:63], a[84:87], v[212:215], v[60:63]
    v_mul_f32 v121, s33, v107
    v_min_f32 v118, s34, v118
    v_mfma_f32_16x16x32_bf16 v[60:63], a[92:95], v[220:223], v[60:63]
    ds_read_b128 v[184:187], v16 offset:256
    v_min_f32 v119, s34, v119
    v_mfma_f32_16x16x32_bf16 v[60:63], a[100:103], v[228:231], v[60:63]
    v_exp_f32 v120, v120
    v_mfma_f32_16x16x32_bf16 v[60:63], a[108:111], v[236:239], v[60:63]
    v_exp_f32 v121, v121
    v_mfma_f32_16x16x32_bf16 v[60:63], a[116:119], v[244:247], v[60:63]
    ds_read_b128 v[132:135], v13 offset:8192
    v_mul_f32 v112, s32, v100
    v_mfma_f32_16x16x32_bf16 v[60:63], a[124:127], v[252:255], v[60:63]
    v_exp_f32 v118, v118
    v_mfma_f32_16x16x32_bf16 v[64:67], a[0:3], v[192:195], 0
    v_exp_f32 v119, v119
    v_mfma_f32_16x16x32_bf16 v[64:67], a[8:11], v[200:203], v[64:67]
    ds_read_b128 v[140:143], v14 offset:8192
    v_add_f32 v122, 1.0, v118
    v_mfma_f32_16x16x32_bf16 v[64:67], a[16:19], v[208:211], v[64:67]
    v_add_f32 v123, 1.0, v119
    v_fmac_f32 v122, v122, v120
    v_mfma_f32_16x16x32_bf16 v[64:67], a[24:27], v[216:219], v[64:67]
    v_fmac_f32 v123, v123, v121
    v_mul_f32 v113, s32, v101
    v_mfma_f32_16x16x32_bf16 v[64:67], a[32:35], v[224:227], v[64:67]
    ds_read_b128 v[148:151], v15 offset:8192
    v_mul_f32 v114, s33, v108
    v_mfma_f32_16x16x32_bf16 v[64:67], a[40:43], v[232:235], v[64:67]
    v_rcp_f32 v122, v122
    v_mfma_f32_16x16x32_bf16 v[64:67], a[48:51], v[240:243], v[64:67]
    v_rcp_f32 v123, v123
    v_mfma_f32_16x16x32_bf16 v[64:67], a[56:59], v[248:251], v[64:67]
    ds_read_b128 v[156:159], v16 offset:8192
    v_fma_f32 v118, -v118, v122, v122
    v_mfma_f32_16x16x32_bf16 v[72:75], a[4:7], v[192:195], 0
    v_fma_f32 v119, -v119, v123, v123
    v_cvt_pk_bf16_f32 v125, v118, v119
    v_mfma_f32_16x16x32_bf16 v[72:75], a[12:15], v[200:203], v[72:75]
    v_mul_f32 v115, s33, v109
    v_min_f32 v112, s34, v112
    v_mfma_f32_16x16x32_bf16 v[72:75], a[20:23], v[208:211], v[72:75]
    ds_read_b128 v[164:167], v13 offset:8448
    v_min_f32 v113, s34, v113
    v_mfma_f32_16x16x32_bf16 v[72:75], a[28:31], v[216:219], v[72:75]
    v_exp_f32 v114, v114
    v_mfma_f32_16x16x32_bf16 v[72:75], a[36:39], v[224:227], v[72:75]
    v_exp_f32 v115, v115
    v_mfma_f32_16x16x32_bf16 v[72:75], a[44:47], v[232:235], v[72:75]
    ds_read_b128 v[172:175], v14 offset:8448
    v_mul_f32 v118, s32, v102
    v_mfma_f32_16x16x32_bf16 v[72:75], a[52:55], v[240:243], v[72:75]
    v_exp_f32 v112, v112
    v_mfma_f32_16x16x32_bf16 v[72:75], a[60:63], v[248:251], v[72:75]
    v_exp_f32 v113, v113
    v_mfma_f32_16x16x32_bf16 v[68:71], a[0:3], v[196:199], 0
    s_waitcnt lgkmcnt(14)
    ds_read_b128 v[180:183], v15 offset:8448
    v_add_f32 v116, 1.0, v112
    v_mfma_f32_16x16x32_bf16 v[68:71], a[8:11], v[204:207], v[68:71]
    v_add_f32 v117, 1.0, v113
    v_fmac_f32 v116, v116, v114
    v_mfma_f32_16x16x32_bf16 v[68:71], a[16:19], v[212:215], v[68:71]
    v_fmac_f32 v117, v117, v115
    v_mul_f32 v119, s32, v103
    v_mfma_f32_16x16x32_bf16 v[68:71], a[24:27], v[220:223], v[68:71]
    v_rcp_f32 v116, v116
    v_mfma_f32_16x16x32_bf16 v[68:71], a[32:35], v[228:231], v[68:71]
    s_waitcnt lgkmcnt(14)
    ds_read_b128 v[188:191], v16 offset:8448
    v_fma_f32 v112, -v112, v116, v116
    v_mfma_f32_16x16x32_bf16 v[68:71], a[40:43], v[236:239], v[68:71]
    v_rcp_f32 v117, v117
    v_mfma_f32_16x16x32_bf16 v[68:71], a[48:51], v[244:247], v[68:71]
    v_fma_f32 v113, -v113, v117, v117
    v_cvt_pk_bf16_f32 v126, v112, v113
    v_mfma_f32_16x16x32_bf16 v[68:71], a[56:59], v[252:255], v[68:71]
    v_mul_f32 v120, s33, v110
    v_mul_f32 v121, s33, v111
    v_mfma_f32_16x16x32_bf16 v[76:79], a[4:7], v[196:199], 0
    v_min_f32 v118, s34, v118
    v_min_f32 v119, s34, v119
    v_mfma_f32_16x16x32_bf16 v[76:79], a[12:15], v[204:207], v[76:79]
    v_exp_f32 v120, v120
    v_mfma_f32_16x16x32_bf16 v[76:79], a[20:23], v[212:215], v[76:79]
    v_exp_f32 v121, v121
    v_mfma_f32_16x16x32_bf16 v[76:79], a[28:31], v[220:223], v[76:79]
    v_exp_f32 v118, v118
    v_mfma_f32_16x16x32_bf16 v[76:79], a[36:39], v[228:231], v[76:79]
    v_exp_f32 v119, v119
    v_mfma_f32_16x16x32_bf16 v[76:79], a[44:47], v[236:239], v[76:79]
    v_add_f32 v122, 1.0, v118
    v_mfma_f32_16x16x32_bf16 v[76:79], a[52:55], v[244:247], v[76:79]
    v_mfma_f32_16x16x32_bf16 v[76:79], a[60:63], v[252:255], v[76:79]
    s_waitcnt lgkmcnt(0)
    v_mfma_f32_16x16x32_bf16 v[80:83], a[128:131], v[128:131], v[48:51]
    s_waitcnt vmcnt(2)
    ds_add_u32 v36, v37
    v_mfma_f32_16x16x32_bf16 v[80:83], a[136:139], v[136:139], v[80:83]
    v_add_f32 v123, 1.0, v119
    v_fmac_f32 v122, v122, v120
    v_mfma_f32_16x16x32_bf16 v[80:83], a[144:147], v[144:147], v[80:83]
    v_fmac_f32 v123, v123, v121
    v_mfma_f32_16x16x32_bf16 v[80:83], a[152:155], v[152:155], v[80:83]
    v_rcp_f32 v122, v122
    v_mfma_f32_16x16x32_bf16 v[80:83], a[160:163], v[160:163], v[80:83]
    v_rcp_f32 v123, v123
    v_mfma_f32_16x16x32_bf16 v[80:83], a[168:171], v[168:171], v[80:83]
    ds_read_b32 v38, v36
    v_fma_f32 v118, -v118, v122, v122
L_stub3:
    s_cbranch_vccnz L_tour_ret
    v_mfma_f32_16x16x32_bf16 v[80:83], a[176:179], v[176:179], v[80:83]
    v_fma_f32 v119, -v119, v123, v123
    v_cvt_pk_bf16_f32 v127, v118, v119
    v_mfma_f32_16x16x32_bf16 v[80:83], a[184:187], v[184:187], v[80:83]
    s_mov_b32 s40, 13312
    v_permlane32_swap_b32 v124, v126
    v_mfma_f32_16x16x32_bf16 v[88:91], a[132:135], v[128:131], v[56:59]
    v_permlane32_swap_b32 v125, v127
    s_nop 0
    v_mfma_f32_16x16x32_bf16 v[88:91], a[140:143], v[136:139], v[88:91]
    buffer_store_dwordx4 v[124:127], v21, s[20:23], s40 offen
    v_mfma_f32_16x16x32_bf16 v[88:91], a[148:151], v[144:147], v[88:91]
    v_mul_f32 v112, s32, v80
    v_mul_f32 v113, s32, v81
    v_mfma_f32_16x16x32_bf16 v[88:91], a[156:159], v[152:155], v[88:91]
    s_waitcnt lgkmcnt(0)
    v_cmp_gt_u32 vcc, 0x4400, v38
    v_mfma_f32_16x16x32_bf16 v[88:91], a[164:167], v[160:163], v[88:91]
    s_cbranch_vccnz L_spin_t0
L_back_t0:
    v_mul_f32 v118, s32, v82
    v_mfma_f32_16x16x32_bf16 v[88:91], a[172:175], v[168:171], v[88:91]
    ds_read_b128 v[28:31], v23 offset:0
    v_mul_f32 v119, s32, v83
    v_min_f32 v112, s34, v112
    v_mfma_f32_16x16x32_bf16 v[88:91], a[180:183], v[176:179], v[88:91]
    ds_read_b128 v[192:195], v13 offset:16384
    v_min_f32 v113, s34, v113
    v_mfma_f32_16x16x32_bf16 v[88:91], a[188:191], v[184:187], v[88:91]
    ds_read_b128 v[200:203], v14 offset:16384
    v_min_f32 v118, s34, v118
    v_mfma_f32_16x16x32_bf16 v[84:87], a[128:131], v[132:135], v[52:55]
    v_min_f32 v119, s34, v119
    v_mfma_f32_16x16x32_bf16 v[84:87], a[136:139], v[140:143], v[84:87]
    ds_read_b128 v[208:211], v15 offset:16384
    v_exp_f32 v112, v112
    v_mfma_f32_16x16x32_bf16 v[84:87], a[144:147], v[148:151], v[84:87]
    v_exp_f32 v113, v113
    v_mfma_f32_16x16x32_bf16 v[84:87], a[152:155], v[156:159], v[84:87]
    ds_read_b128 v[216:219], v16 offset:16384
    v_add_f32 v116, 1.0, v112
    v_mfma_f32_16x16x32_bf16 v[84:87], a[160:163], v[164:167], v[84:87]
    ds_read_b128 v[224:227], v13 offset:16640
    v_exp_f32 v118, v118
    v_mfma_f32_16x16x32_bf16 v[84:87], a[168:171], v[172:175], v[84:87]
    v_exp_f32 v119, v119
    v_mfma_f32_16x16x32_bf16 v[84:87], a[176:179], v[180:183], v[84:87]
    ds_read_b128 v[232:235], v14 offset:16640
    v_add_f32 v117, 1.0, v113
    v_mfma_f32_16x16x32_bf16 v[84:87], a[184:187], v[188:191], v[84:87]
    v_add_f32 v122, 1.0, v118
    v_add_f32 v123, 1.0, v119
    v_mfma_f32_16x16x32_bf16 v[92:95], a[132:135], v[132:135], v[60:63]
    ds_read_b128 v[240:243], v15 offset:16640
    s_add_u32 s36, s36, 1024
    s_waitcnt lgkmcnt(7)
    v_mfma_f32_16x16x32_bf16 v[92:95], a[140:143], v[140:143], v[92:95]
    buffer_store_dwordx4 v[28:31], v24, s[20:23], s36 offen sc1
    v_mfma_f32_16x16x32_bf16 v[92:95], a[148:151], v[148:151], v[92:95]
    ds_read_b128 v[248:251], v16 offset:16640
    v_mul_f32 v114, s33, v88
    v_mfma_f32_16x16x32_bf16 v[92:95], a[156:159], v[156:159], v[92:95]
    ds_read_b128 v[196:199], v13 offset:24576
    v_mul_f32 v115, s33, v89
    v_mul_f32 v120, s33, v90
    v_mfma_f32_16x16x32_bf16 v[92:95], a[164:167], v[164:167], v[92:95]
    v_mul_f32 v121, s33, v91
    v_mfma_f32_16x16x32_bf16 v[92:95], a[172:175], v[172:175], v[92:95]
    ds_read_b128 v[204:207], v14 offset:24576
    v_mfma_f32_16x16x32_bf16 v[92:95], a[180:183], v[180:183], v[92:95]
    v_exp_f32 v114, v114
    v_mfma_f32_16x16x32_bf16 v[92:95], a[188:191], v[188:191], v[92:95]
    ds_read_b128 v[212:215], v15 offset:24576
    v_exp_f32 v115, v115
    v_mfma_f32_16x16x32_bf16 v[48:51], a[64:67], v[128:131], v[64:67]
    v_exp_f32 v120, v120
    v_mfma_f32_16x16x32_bf16 v[48:51], a[72:75], v[136:139], v[48:51]
    ds_read_b128 v[220:223], v16 offset:24576
    v_fmac_f32 v116, v116, v114
    v_mfma_f32_16x16x32_bf16 v[48:51], a[80:83], v[144:147], v[48:51]
    ds_read_b128 v[228:231], v13 offset:24832
    v_fmac_f32 v117, v117, v115
    v_mfma_f32_16x16x32_bf16 v[48:51], a[88:91], v[152:155], v[48:51]
    v_exp_f32 v121, v121
    v_fmac_f32 v122, v122, v120
    v_mfma_f32_16x16x32_bf16 v[48:51], a[96:99], v[160:163], v[48:51]
    ds_read_b128 v[236:239], v14 offset:24832
    v_fmac_f32 v123, v123, v121
    v_mfma_f32_16x16x32_bf16 v[48:51], a[104:107], v[168:171], v[48:51]
    v_rcp_f32 v116, v116
    v_mfma_f32_16x16x32_bf16 v[48:51], a[112:115], v[176:179], v[48:51]
    ds_read_b128 v[244:247], v15 offset:24832
    v_rcp_f32 v117, v117
    v_mfma_f32_16x16x32_bf16 v[48:51], a[120:123], v[184:187], v[48:51]
    v_rcp_f32 v122, v122
    v_mfma_f32_16x16x32_bf16 v[56:59], a[68:71], v[128:131], v[72:75]
    s_waitcnt lgkmcnt(14)
    ds_read_b128 v[252:255], v16 offset:24832
    v_fma_f32 v112, -v112, v116, v116
    v_mfma_f32_16x16x32_bf16 v[56:59], a[76:79], v[136:139], v[56:59]
    v_rcp_f32 v123, v123
    v_mfma_f32_16x16x32_bf16 v[56:59], a[84:87], v[144:147], v[56:59]
    v_fma_f32 v113, -v113, v117, v117
    v_fma_f32 v118, -v118, v122, v122
    v_fma_f32 v119, -v119, v123, v123
    v_mfma_f32_16x16x32_bf16 v[56:59], a[92:95], v[152:155], v[56:59]
    v_cvt_pk_bf16_f32 v124, v112, v113
    v_cvt_pk_bf16_f32 v125, v118, v119
    v_mfma_f32_16x16x32_bf16 v[56:59], a[100:103], v[160:163], v[56:59]
    v_mul_f32 v112, s32, v84
    v_mul_f32 v113, s32, v85
    v_mfma_f32_16x16x32_bf16 v[56:59], a[108:111], v[168:171], v[56:59]
    v_mul_f32 v118, s32, v86
    v_mul_f32 v119, s32, v87
    v_min_f32 v112, s34, v112
    v_mfma_f32_16x16x32_bf16 v[56:59], a[116:119], v[176:179], v[56:59]
    v_min_f32 v113, s34, v113
    v_min_f32 v118, s34, v118
    v_mfma_f32_16x16x32_bf16 v[56:59], a[124:127], v[184:187], v[56:59]
    v_min_f32 v119, s34, v119
    s_waitcnt lgkmcnt(0)
    v_mfma_f32_16x16x32_bf16 v[96:99], a[128:131], v[192:195], v[48:51]
    v_exp_f32 v112, v112
    v_mfma_f32_16x16x32_bf16 v[96:99], a[136:139], v[200:203], v[96:99]
    v_exp_f32 v113, v113
    v_add_f32 v116, 1.0, v112
    v_mfma_f32_16x16x32_bf16 v[96:99], a[144:147], v[208:211], v[96:99]
    v_exp_f32 v118, v118
    v_mfma_f32_16x16x32_bf16 v[96:99], a[152:155], v[216:219], v[96:99]
    v_exp_f32 v119, v119
    v_mfma_f32_16x16x32_bf16 v[96:99], a[160:163], v[224:227], v[96:99]
    v_add_f32 v117, 1.0, v113
    v_add_f32 v122, 1.0, v118
    v_add_f32 v123, 1.0, v119
    v_mfma_f32_16x16x32_bf16 v[96:99], a[168:171], v[232:235], v[96:99]
    v_mul_f32 v114, s33, v92
    v_mul_f32 v115, s33, v93
    v_mfma_f32_16x16x32_bf16 v[96:99], a[176:179], v[240:243], v[96:99]
    v_mul_f32 v120, s33, v94
    v_mul_f32 v121, s33, v95
    v_mfma_f32_16x16x32_bf16 v[96:99], a[184:187], v[248:251], v[96:99]
    v_exp_f32 v114, v114
    v_mfma_f32_16x16x32_bf16 v[104:107], a[132:135], v[192:195], v[56:59]
    v_exp_f32 v115, v115
    v_fmac_f32 v116, v116, v114
    v_mfma_f32_16x16x32_bf16 v[104:107], a[140:143], v[200:203], v[104:107]
    v_exp_f32 v120, v120
    v_mfma_f32_16x16x32_bf16 v[104:107], a[148:151], v[208:211], v[104:107]
    v_exp_f32 v121, v121
    v_mfma_f32_16x16x32_bf16 v[104:107], a[156:159], v[216:219], v[104:107]
    v_fmac_f32 v117, v117, v115
    v_fmac_f32 v122, v122, v120
    v_mfma_f32_16x16x32_bf16 v[104:107], a[164:167], v[224:227], v[104:107]
    v_fmac_f32 v123, v123, v121
    v_rcp_f32 v116, v116
    v_mfma_f32_16x16x32_bf16 v[104:107], a[172:175], v[232:235], v[104:107]
    v_rcp_f32 v117, v117
    v_mfma_f32_16x16x32_bf16 v[104:107], a[180:183], v[240:243], v[104:107]
    v_rcp_f32 v122, v122
    v_mfma_f32_16x16x32_bf16 v[104:107], a[188:191], v[248:251], v[104:107]
    v_rcp_f32 v123, v123
    v_fma_f32 v112, -v112, v116, v116
    v_mfma_f32_16x16x32_bf16 v[52:55], a[64:67], v[132:135], v[68:71]
    v_fma_f32 v113, -v113, v117, v117
    v_fma_f32 v118, -v118, v122, v122
    v_mfma_f32_16x16x32_bf16 v[52:55], a[72:75], v[140:143], v[52:55]
    v_fma_f32 v119, -v119, v123, v123
    v_cvt_pk_bf16_f32 v126, v112, v113
    v_mfma_f32_16x16x32_bf16 v[52:55], a[80:83], v[148:151], v[52:55]
    v_cvt_pk_bf16_f32 v127, v118, v119
    s_mov_b32 s40, 14336
    v_mfma_f32_16x16x32_bf16 v[52:55], a[88:91], v[156:159], v[52:55]
    v_permlane32_swap_b32 v124, v126
    v_permlane32_swap_b32 v125, v127
    s_nop 0
    v_mfma_f32_16x16x32_bf16 v[52:55], a[96:99], v[164:167], v[52:55]
    buffer_store_dwordx4 v[124:127], v21, s[20:23], s40 offen
    v_mfma_f32_16x16x32_bf16 v[52:55], a[104:107], v[172:175], v[52:55]
    v_mul_f32 v112, s32, v96
    v_mul_f32 v113, s32, v97
    v_mfma_f32_16x16x32_bf16 v[52:55], a[112:115], v[180:183], v[52:55]
    v_mul_f32 v118, s32, v98
    v_mul_f32 v119, s32, v99
    v_min_f32 v112, s34, v112
    v_mfma_f32_16x16x32_bf16 v[52:55], a[120:123], v[188:191], v[52:55]
    v_min_f32 v113, s34, v113
    v_min_f32 v118, s34, v118
    v_mfma_f32_16x16x32_bf16 v[60:63], a[68:71], v[132:135], v[76:79]
    v_min_f32 v119, s34, v119
    v_mul_f32 v114, s33, v104
    v_mfma_f32_16x16x32_bf16 v[60:63], a[76:79], v[140:143], v[60:63]
    v_exp_f32 v112, v112
    v_mfma_f32_16x16x32_bf16 v[60:63], a[84:87], v[148:151], v[60:63]
    v_exp_f32 v113, v113
    v_add_f32 v116, 1.0, v112
    v_mfma_f32_16x16x32_bf16 v[60:63], a[92:95], v[156:159], v[60:63]
    v_exp_f32 v118, v118
    v_mfma_f32_16x16x32_bf16 v[60:63], a[100:103], v[164:167], v[60:63]
    v_exp_f32 v119, v119
    v_mfma_f32_16x16x32_bf16 v[60:63], a[108:111], v[172:175], v[60:63]
    v_add_f32 v117, 1.0, v113
    v_add_f32 v122, 1.0, v118
    v_mfma_f32_16x16x32_bf16 v[60:63], a[116:119], v[180:183], v[60:63]
    v_add_f32 v123, 1.0, v119
    v_mul_f32 v115, s33, v105
    v_mul_f32 v120, s33, v106
    v_mfma_f32_16x16x32_bf16 v[60:63], a[124:127], v[188:191], v[60:63]
    v_mul_f32 v121, s33, v107
    v_mfma_f32_16x16x32_bf16 v[100:103], a[128:131], v[196:199], v[52:55]
    v_exp_f32 v114, v114
    v_mfma_f32_16x16x32_bf16 v[100:103], a[136:139], v[204:207], v[100:103]
    v_exp_f32 v115, v115
    v_fmac_f32 v116, v116, v114
    v_mfma_f32_16x16x32_bf16 v[100:103], a[144:147], v[212:215], v[100:103]
    v_exp_f32 v120, v120
    v_mfma_f32_16x16x32_bf16 v[100:103], a[152:155], v[220:223], v[100:103]
    v_exp_f32 v121, v121
    v_mfma_f32_16x16x32_bf16 v[100:103], a[160:163], v[228:231], v[100:103]
    v_fmac_f32 v117, v117, v115
    v_fmac_f32 v122, v122, v120
    v_mfma_f32_16x16x32_bf16 v[100:103], a[168:171], v[236:239], v[100:103]
    v_fmac_f32 v123, v123, v121
    v_rcp_f32 v116, v116
    v_mfma_f32_16x16x32_bf16 v[100:103], a[176:179], v[244:247], v[100:103]
    v_rcp_f32 v117, v117
    v_mfma_f32_16x16x32_bf16 v[100:103], a[184:187], v[252:255], v[100:103]
    v_rcp_f32 v122, v122
    v_mfma_f32_16x16x32_bf16 v[108:111], a[132:135], v[196:199], v[60:63]
    v_rcp_f32 v123, v123
    v_fma_f32 v112, -v112, v116, v116
    v_mfma_f32_16x16x32_bf16 v[108:111], a[140:143], v[204:207], v[108:111]
    v_fma_f32 v113, -v113, v117, v117
    v_fma_f32 v118, -v118, v122, v122
    v_mfma_f32_16x16x32_bf16 v[108:111], a[148:151], v[212:215], v[108:111]
    v_fma_f32 v119, -v119, v123, v123
    v_cvt_pk_bf16_f32 v124, v112, v113
    v_mfma_f32_16x16x32_bf16 v[108:111], a[156:159], v[220:223], v[108:111]
    v_cvt_pk_bf16_f32 v125, v118, v119
    s_mov_b32 s40, 15360
    v_mfma_f32_16x16x32_bf16 v[108:111], a[164:167], v[228:231], v[108:111]
    buffer_store_dwordx2 v[124:125], v32, s[20:23], s40 offen
    v_mul_f32 v112, s32, v100
    v_mfma_f32_16x16x32_bf16 v[108:111], a[172:175], v[236:239], v[108:111]
    v_mul_f32 v113, s32, v101
    v_mul_f32 v118, s32, v102
    v_mfma_f32_16x16x32_bf16 v[108:111], a[180:183], v[244:247], v[108:111]
    v_mul_f32 v119, s32, v103
    v_min_f32 v112, s34, v112
    v_mfma_f32_16x16x32_bf16 v[108:111], a[188:191], v[252:255], v[108:111]
    v_min_f32 v113, s34, v113
    v_min_f32 v118, s34, v118
    v_min_f32 v119, s34, v119
    v_exp_f32 v112, v112
    v_exp_f32 v113, v113
    v_exp_f32 v118, v118
    v_exp_f32 v119, v119
    v_add_f32 v116, 1.0, v112
    v_add_f32 v117, 1.0, v113
    v_add_f32 v122, 1.0, v118
    v_add_f32 v123, 1.0, v119
    v_mul_f32 v114, s33, v108
    v_mul_f32 v115, s33, v109
    v_mul_f32 v120, s33, v110
    v_mul_f32 v121, s33, v111
    v_exp_f32 v114, v114
    v_exp_f32 v115, v115
    v_exp_f32 v120, v120
    v_exp_f32 v121, v121
    v_fmac_f32 v116, v116, v114
    v_fmac_f32 v117, v117, v115
    v_fmac_f32 v122, v122, v120
    v_fmac_f32 v123, v123, v121
    v_rcp_f32 v116, v116
    v_rcp_f32 v117, v117
    v_rcp_f32 v122, v122
    v_rcp_f32 v123, v123
    v_fma_f32 v112, -v112, v116, v116
    v_fma_f32 v113, -v113, v117, v117
    v_fma_f32 v118, -v118, v122, v122
    v_fma_f32 v119, -v119, v123, v123
    v_cvt_pk_bf16_f32 v126, v112, v113
    v_cvt_pk_bf16_f32 v127, v118, v119
    s_mov_b32 s40, 15360
    buffer_store_dwordx2 v[126:127], v33, s[20:23], s40 offen
L_end:
    s_endpgm
.section .rodata,"a"
.p2align 6
.amdhsa_kernel standalone__autoregressive_conv_wavernn__speech_kernel
  .amdhsa_next_free_vgpr 512
  .amdhsa_next_free_sgpr 102
  .amdhsa_accum_offset 256
  .amdhsa_group_segment_fixed_size 0
  .amdhsa_kernarg_size 40
  .amdhsa_user_sgpr_count 2
  .amdhsa_user_sgpr_kernarg_segment_ptr 1
  .amdhsa_system_sgpr_workgroup_id_x 1
  .amdhsa_float_denorm_mode_32 3
.end_amdhsa_kernel
```
